```python
import torch

def _softmax(x, axis=-1):
    return torch.softmax(x, dim=axis)
def _gelu(x):
    return torch.nn.functional.gelu(x, approximate="tanh")
def _silu(x):
    return torch.nn.functional.silu(x)
def _sigmoid(x):
    return torch.sigmoid(x)
def _layernorm(x, axis=-1, eps=1e-5):
    m = x.mean(dim=axis, keepdim=True)
    v = x.var(dim=axis, keepdim=True, unbiased=False)
    return (x - m) / torch.sqrt(v + eps)
def _scatter_add(tgt, idx, src, axis=0):
    return tgt.clone().index_add_(axis, idx, src)
def _segment_sum(src, seg, n):
    out = torch.zeros((n,) + src.shape[1:], dtype=src.dtype)
    return out.index_add_(0, seg, src)
def _pad(x, pw):
    flat = tuple(v for pair in reversed(pw) for v in pair)
    return torch.nn.functional.pad(x, flat)

kernel_name = 'standalone__edge_featured_mpnn_egc__graph'

def setup_inputs():

    _w = (lambda a: (lambda t: t.to(torch.bfloat16) if t.is_floating_point() else t)(torch.as_tensor(a)))
    N, deg, D, De = 25000, 32, 64, max(4, 1)
    E = N * deg
    return {
        "x": _w((lambda *s: torch.randn(*s, dtype=torch.bfloat16) * 0.2)(N, D)),
        "e_attr": _w((lambda *s: torch.randn(*s, dtype=torch.bfloat16) * 0.2)(E, De)),
        "src": _w((lambda lo, hi, *s: torch.randint(lo, hi, s))(0, N, E).to(torch.int64)),
        "dst": _w((lambda lo, hi, *s: torch.randint(lo, hi, s))(0, N, E).to(torch.int64)),
        "u_w": _w((lambda *s: torch.randn(*s, dtype=torch.bfloat16) * 0.05)(D, D)),
        "v_w": _w((lambda *s: torch.randn(*s, dtype=torch.bfloat16) * 0.05)(D, D)),
        "g_w": _w((lambda *s: torch.randn(*s, dtype=torch.bfloat16) * 0.2)(2 * D + De, D)),
    }

def reference(x, e_attr, src, dst, u_w, v_w, g_w):
    N, D = x.shape
    g_in = torch.concatenate([x[dst], x[src], e_attr], axis=-1)
    eta = _sigmoid(g_in @ g_w)
    hv = x @ v_w
    msg = eta * hv[src]
    agg = _segment_sum(msg, dst, N)
    return _silu(x @ u_w + agg)
```

```asm
; @launch grid=(256,1,1) block=(512,1,1) lds=161904
.amdgcn_target "amdgcn-amd-amdhsa--gfx950"
.text
.globl standalone__edge_featured_mpnn_egc__graph_kernel
.p2align 8
.type standalone__edge_featured_mpnn_egc__graph_kernel,@function
standalone__edge_featured_mpnn_egc__graph_kernel:
    s_cmp_ge_u32 s2, 256
    s_cbranch_scc1 L_END
    s_load_dwordx8 s[68:75], s[0:1], 0
    s_load_dwordx4 s[28:31], s[0:1], 32
    s_load_dwordx2 s[100:101], s[0:1], 48
    s_load_dwordx4 s[4:7], s[0:1], 64
    s_load_dwordx2 s[76:77], s[0:1], 56
    s_and_b32 s3, s2, 7
    s_lshr_b32 s11, s2, 3
    s_mov_b32 s59, s11
    s_mul_i32 s10, s3, 31
    s_min_u32 s43, s3, 2
    s_add_u32 s10, s10, s11
    s_add_u32 s10, s10, s43
    s_cmp_lt_u32 s2, 250
    s_cselect_b32 s58, s10, s2
    s_mul_i32 s10, s3, 32
    s_min_u32 s3, s3, 0
    s_add_u32 s2, s11, s10
    s_add_u32 s2, s2, s3
    s_getpc_b64 s[78:79]
L_PC:
    v_lshlrev_b32 v1, 5, v0
    v_add_u32 v1, s11, v1
    v_lshlrev_b32 v1, 7, v1
    s_mov_b32 s3, L_CODE_END-L_PC
    v_cmp_gt_u32 vcc, s3, v1
    s_nop 0
    s_and_saveexec_b64 s[84:85], vcc
    s_cbranch_execz L_NOCPF
    global_load_dword v2, v1, s[78:79]
L_NOCPF:
    s_mov_b64 exec, s[84:85]
    v_mov_b32 v212, v0
    v_and_b32 v213, 63, v212
    v_lshrrev_b32 v214, 6, v212
    s_nop 0
    v_readfirstlane_b32 s32, v214
    v_lshlrev_b32 v152, 3, v212
    v_lshlrev_b32 v153, 4, v212
    v_mov_b32 v154, 1
    s_mul_i32 s56, s58, 12800
    s_mul_i32 s57, s58, 25600
    v_lshlrev_b32 v216, 2, v212
    v_add_u32 v216, 113664, v216
    v_mov_b32 v217, 0
    s_movk_i32 s42, 256
    v_cmp_gt_u32 vcc, s42, v212
    s_nop 0
    s_and_saveexec_b64 s[84:85], vcc
    ds_write_b32 v216, v217
    s_mov_b64 exec, s[84:85]
    s_movk_i32 s42, 132
    v_cmp_gt_u32 vcc, s42, v212
    s_nop 0
    s_and_saveexec_b64 s[84:85], vcc
    ds_write_b32 v216, v217 offset:14432
    s_mov_b64 exec, s[84:85]
    s_mov_b32 s54, 0x30d400
    s_mov_b32 s55, 0x20000
    s_mov_b32 s50, 0x30d400
    s_mov_b32 s51, 0x20000
    s_mov_b32 s46, 0x61a800
    s_mov_b32 s47, 0x20000
    s_mov_b32 s14, 0x30d400
    s_mov_b32 s15, 0x20000
    s_mov_b32 s22, 0x3e800
    s_mov_b32 s23, 0x20000
    s_mov_b32 s26, 0x100
    s_mov_b32 s27, 0x20000
    s_mov_b32 s18, 0x92f900
    s_mov_b32 s19, 0x20000
    s_waitcnt lgkmcnt(0)
    s_cmp_ge_u32 s58, 250
    s_cbranch_scc1 L_JAN
    s_mov_b64 s[52:53], s[74:75]
    s_add_u32 s3, s56, 0
    buffer_load_dwordx2 v[104:105], v152, s[52:55], s3 offen nt
    s_add_u32 s3, s56, 4096
    buffer_load_dwordx2 v[116:117], v152, s[52:55], s3 offen nt
    s_add_u32 s3, s56, 8192
    buffer_load_dwordx2 v[128:129], v152, s[52:55], s3 offen nt
    s_mov_b64 s[48:49], s[72:73]
    s_mov_b64 s[44:45], s[70:71]
    s_cmp_lg_u32 s32, 0
    s_cbranch_scc1 L_NOR3A
    s_add_u32 s3, s56, 12288
    buffer_load_dwordx2 v[140:141], v152, s[52:55], s3 offen nt
    s_add_u32 s3, s56, 12288
    buffer_load_dwordx2 v[142:143], v152, s[48:51], s3 offen nt
    s_add_u32 s3, s57, 24576
    buffer_load_dwordx4 v[144:147], v153, s[44:47], s3 offen nt
L_NOR3A:
    s_barrier
    s_add_u32 s3, s56, 0
    buffer_load_dwordx2 v[106:107], v152, s[48:51], s3 offen nt
    s_add_u32 s3, s56, 4096
    buffer_load_dwordx2 v[118:119], v152, s[48:51], s3 offen nt
    s_add_u32 s3, s56, 8192
    buffer_load_dwordx2 v[130:131], v152, s[48:51], s3 offen nt
    s_add_u32 s3, s57, 0
    buffer_load_dwordx4 v[108:111], v153, s[44:47], s3 offen nt
    s_add_u32 s3, s57, 8192
    buffer_load_dwordx4 v[120:123], v153, s[44:47], s3 offen nt
    s_add_u32 s3, s57, 16384
    buffer_load_dwordx4 v[132:135], v153, s[44:47], s3 offen nt
    s_mov_b64 s[8:9], s[6:7]
    s_add_u32 s20, s8, 0xa00000
    s_addc_u32 s21, s9, 0
    s_mov_b64 s[24:25], s[4:5]
    s_mov_b64 s[16:17], s[8:9]
    s_mov_b64 s[12:13], s[68:69]
    s_movk_i32 s3, -98
    s_mov_b32 s43, 113664
    s_waitcnt vmcnt(8)
    v_mul_u32_u24 v112, 0x5398, v104
    v_lshrrev_b32 v112, 21, v112
    v_mad_i32_i24 v104, v112, s3, v104
    v_lshl_add_u32 v112, v112, 2, s43
    ds_add_rtn_u32 v114, v112, v154
    v_mul_u32_u24 v113, 0x5398, v105
    v_lshrrev_b32 v113, 21, v113
    v_mad_i32_i24 v105, v113, s3, v105
    v_lshl_add_u32 v113, v113, 2, s43
    ds_add_rtn_u32 v115, v113, v154
    s_waitcnt vmcnt(7)
    v_mul_u32_u24 v124, 0x5398, v116
    v_lshrrev_b32 v124, 21, v124
    v_mad_i32_i24 v116, v124, s3, v116
    v_lshl_add_u32 v124, v124, 2, s43
    ds_add_rtn_u32 v126, v124, v154
    v_mul_u32_u24 v125, 0x5398, v117
    v_lshrrev_b32 v125, 21, v125
    v_mad_i32_i24 v117, v125, s3, v117
    v_lshl_add_u32 v125, v125, 2, s43
    ds_add_rtn_u32 v127, v125, v154
    s_waitcnt vmcnt(6)
    v_mul_u32_u24 v136, 0x5398, v128
    v_lshrrev_b32 v136, 21, v136
    v_mad_i32_i24 v128, v136, s3, v128
    v_lshl_add_u32 v136, v136, 2, s43
    ds_add_rtn_u32 v138, v136, v154
    v_mul_u32_u24 v137, 0x5398, v129
    v_lshrrev_b32 v137, 21, v137
    v_mad_i32_i24 v129, v137, s3, v129
    v_lshl_add_u32 v137, v137, 2, s43
    ds_add_rtn_u32 v139, v137, v154
    s_cmp_lg_u32 s32, 0
    s_cbranch_scc1 L_NOR3B
    v_mul_u32_u24 v148, 0x5398, v140
    v_lshrrev_b32 v148, 21, v148
    v_mad_i32_i24 v140, v148, s3, v140
    v_lshl_add_u32 v148, v148, 2, s43
    ds_add_rtn_u32 v150, v148, v154
    v_mul_u32_u24 v149, 0x5398, v141
    v_lshrrev_b32 v149, 21, v149
    v_mad_i32_i24 v141, v149, s3, v141
    v_lshl_add_u32 v149, v149, 2, s43
    ds_add_rtn_u32 v151, v149, v154
L_NOR3B:
    s_waitcnt lgkmcnt(0)
    s_barrier
    v_lshlrev_b32 v216, 4, v213
    v_add_u32 v216, 113664, v216
    ds_read_b128 v[224:227], v216
    s_waitcnt lgkmcnt(0)
    v_add_u32 v218, v224, v225
    v_add3_u32 v218, v218, v226, v227
    v_mov_b32 v217, v218
    s_nop 1
    v_add_u32_dpp v217, v217, v217 row_shr:1 row_mask:0xf bank_mask:0xf bound_ctrl:0
    s_nop 1
    v_add_u32_dpp v217, v217, v217 row_shr:2 row_mask:0xf bank_mask:0xf bound_ctrl:0
    s_nop 1
    v_add_u32_dpp v217, v217, v217 row_shr:4 row_mask:0xf bank_mask:0xf bound_ctrl:0
    s_nop 1
    v_add_u32_dpp v217, v217, v217 row_shr:8 row_mask:0xf bank_mask:0xf bound_ctrl:0
    s_nop 1
    v_add_u32_dpp v217, v217, v217 row_bcast:15 row_mask:0xa bank_mask:0xf
    s_nop 1
    v_add_u32_dpp v217, v217, v217 row_bcast:31 row_mask:0xc bank_mask:0xf
    v_sub_u32 v228, v217, v218
    v_add_u32 v229, v228, v224
    v_add_u32 v230, v229, v225
    v_add_u32 v231, v230, v226
    ds_write_b128 v216, v[228:231] offset:1024
    s_mov_b32 s3, 0x80000000
    v_lshlrev_b32 v224, 16, v224
    v_or3_b32 v224, v224, v228, s3
    v_lshlrev_b32 v225, 16, v225
    v_or3_b32 v225, v225, v229, s3
    v_lshlrev_b32 v226, 16, v226
    v_or3_b32 v226, v226, v230, s3
    v_lshlrev_b32 v227, 16, v227
    v_or3_b32 v227, v227, v231, s3
    s_waitcnt lgkmcnt(0)
    ds_read_b32 v112, v112 offset:1024
    ds_read_b32 v113, v113 offset:1024
    ds_read_b32 v124, v124 offset:1024
    ds_read_b32 v125, v125 offset:1024
    ds_read_b32 v136, v136 offset:1024
    ds_read_b32 v137, v137 offset:1024
    s_cmp_lg_u32 s32, 0
    s_cbranch_scc1 L_NOR3D
    ds_read_b32 v148, v148 offset:1024
    ds_read_b32 v149, v149 offset:1024
L_NOR3D:
    s_mov_b32 s43, 75264
    s_cmp_lg_u32 s32, 0
    s_cbranch_scc1 L_NOR3C
    v_lshlrev_b32 v142, 7, v142
    v_lshl_or_b32 v142, v140, 25, v142
    s_waitcnt lgkmcnt(0)
    v_add_u32 v148, v148, v150
    v_mad_u32_u24 v148, v148, 12, s43
    ds_write_b32 v148, v142 offset:8
    v_lshlrev_b32 v143, 7, v143
    v_lshl_or_b32 v143, v141, 25, v143
    v_add_u32 v149, v149, v151
    v_mad_u32_u24 v149, v149, 12, s43
    ds_write_b32 v149, v143 offset:8
    ds_write2_b32 v148, v144, v145 offset0:0 offset1:1
    ds_write2_b32 v149, v146, v147 offset0:0 offset1:1
L_NOR3C:
    s_waitcnt vmcnt(5)
    v_lshlrev_b32 v106, 7, v106
    v_lshl_or_b32 v106, v104, 25, v106
    s_waitcnt lgkmcnt(5)
    v_add_u32 v112, v112, v114
    v_mad_u32_u24 v112, v112, 12, s43
    ds_write_b32 v112, v106 offset:8
    v_lshlrev_b32 v107, 7, v107
    v_lshl_or_b32 v107, v105, 25, v107
    s_waitcnt lgkmcnt(5)
    v_add_u32 v113, v113, v115
    v_mad_u32_u24 v113, v113, 12, s43
    ds_write_b32 v113, v107 offset:8
    s_waitcnt vmcnt(4)
    v_lshlrev_b32 v118, 7, v118
    v_lshl_or_b32 v118, v116, 25, v118
    s_waitcnt lgkmcnt(5)
    v_add_u32 v124, v124, v126
    v_mad_u32_u24 v124, v124, 12, s43
    ds_write_b32 v124, v118 offset:8
    v_lshlrev_b32 v119, 7, v119
    v_lshl_or_b32 v119, v117, 25, v119
    s_waitcnt lgkmcnt(5)
    v_add_u32 v125, v125, v127
    v_mad_u32_u24 v125, v125, 12, s43
    ds_write_b32 v125, v119 offset:8
    s_waitcnt vmcnt(3)
    v_lshlrev_b32 v130, 7, v130
    v_lshl_or_b32 v130, v128, 25, v130
    s_waitcnt lgkmcnt(5)
    v_add_u32 v136, v136, v138
    v_mad_u32_u24 v136, v136, 12, s43
    ds_write_b32 v136, v130 offset:8
    v_lshlrev_b32 v131, 7, v131
    v_lshl_or_b32 v131, v129, 25, v131
    s_waitcnt lgkmcnt(5)
    v_add_u32 v137, v137, v139
    v_mad_u32_u24 v137, v137, 12, s43
    ds_write_b32 v137, v131 offset:8
    s_waitcnt vmcnt(2)
    ds_write2_b32 v112, v108, v109 offset0:0 offset1:1
    ds_write2_b32 v113, v110, v111 offset0:0 offset1:1
    s_waitcnt vmcnt(1)
    ds_write2_b32 v124, v120, v121 offset0:0 offset1:1
    ds_write2_b32 v125, v122, v123 offset0:0 offset1:1
    s_waitcnt vmcnt(0)
    ds_write2_b32 v136, v132, v133 offset0:0 offset1:1
    ds_write2_b32 v137, v134, v135 offset0:0 offset1:1
    s_waitcnt lgkmcnt(0)
    s_barrier
    v_add_u32 v216, 75264, v153
    s_mul_i32 s10, s58, 38528
    ds_read_b128 v[104:107], v216 offset:0
    ds_read_b128 v[108:111], v216 offset:8192
    ds_read_b128 v[112:115], v216 offset:16384
    ds_read_b128 v[116:119], v216 offset:24576
    ds_read_b128 v[120:123], v216 offset:32768
    s_add_u32 s3, s10, 0
    s_waitcnt lgkmcnt(4)
    buffer_store_dwordx4 v[104:107], v153, s[16:19], s3 offen sc1
    s_add_u32 s3, s10, 8192
    s_waitcnt lgkmcnt(3)
    buffer_store_dwordx4 v[108:111], v153, s[16:19], s3 offen sc1
    s_add_u32 s3, s10, 16384
    s_waitcnt lgkmcnt(2)
    buffer_store_dwordx4 v[112:115], v153, s[16:19], s3 offen sc1
    s_add_u32 s3, s10, 24576
    s_waitcnt lgkmcnt(1)
    buffer_store_dwordx4 v[116:119], v153, s[16:19], s3 offen sc1
    s_add_u32 s3, s10, 32768
    s_movk_i32 s42, 352
    v_cmp_gt_u32 vcc, s42, v212
    s_nop 0
    s_and_saveexec_b64 s[84:85], vcc
    s_waitcnt lgkmcnt(0)
    buffer_store_dwordx4 v[120:123], v153, s[16:19], s3 offen sc1
    s_mov_b64 exec, s[84:85]
L_CONS1:
    s_cmp_eq_u32 s32, 1
    s_cselect_b64 exec, 1, 0
    buffer_load_dwordx2 v[178:179], off, s[24:27], 0 sc1
    s_mov_b64 exec, -1
    v_and_b32 v75, 7, v213
    v_lshrrev_b32 v74, 3, v212
    s_mov_b32 s42, 154112
    v_mul_lo_u32 v74, v74, s42
    v_mad_u32_u24 v74, v75, 12, v74
    v_and_b32 v215, 31, v213
    v_lshrrev_b32 v216, 5, v213
    v_lshlrev_b32 v211, 3, v215
    s_mov_b32 s38, 0x30800000
    s_mov_b32 s39, s38
    s_mov_b32 s33, 0
    s_mov_b32 s34, 40
    s_lshl_b32 s36, s32, 12
    s_add_u32 s36, s36, 129136
    v_mov_b32 v92, 0x3f80
    v_mov_b32 v93, 0
    v_and_b32 v219, 5, v215
    v_lshrrev_b32 v220, 4, v215
    v_lshl_or_b32 v219, v220, 1, v219
    v_bfe_u32 v220, v215, 1, 1
    v_bfe_u32 v221, v215, 3, 1
    v_lshl_or_b32 v220, v221, 1, v220
    v_lshlrev_b32 v221, 2, v216
    v_sub_u32 v221, v219, v221
    v_mov_b32 v222, 0x3f80
    v_cmp_eq_u32 vcc, 0, v221
    s_nop 1
    v_cndmask_b32 v94, 0, v222, vcc
    v_cmp_eq_u32 vcc, 1, v221
    s_nop 1
    v_cndmask_b32 v94, v94, 1.0, vcc
    v_cmp_eq_u32 vcc, 2, v221
    s_nop 1
    v_cndmask_b32 v95, 0, v222, vcc
    v_cmp_eq_u32 vcc, 3, v221
    s_nop 1
    v_cndmask_b32 v95, v95, 1.0, vcc
    v_lshl_add_u32 v221, v220, 3, v219
    v_lshlrev_b32 v221, 7, v221
    v_add_u32 v221, s36, v221
    v_bfe_u32 v222, v215, 1, 3
    v_xor_b32 v222, v222, v216
    v_xor_b32 v223, 0, v222
    v_lshl_add_u32 v204, v223, 4, v221
    v_xor_b32 v223, 2, v222
    v_lshl_add_u32 v205, v223, 4, v221
    v_xor_b32 v223, 4, v222
    v_lshl_add_u32 v206, v223, 4, v221
    v_xor_b32 v223, 6, v222
    v_lshl_add_u32 v207, v223, 4, v221
    v_lshl_add_u32 v223, v219, 2, v220
    s_lshl_b32 s42, s32, 8
    s_add_u32 s42, s42, 91520
    v_lshl_add_u32 v236, v223, 3, s42
    s_lshl_b32 s42, s32, 5
    s_add_u32 s42, s42, 124032
    v_lshl_add_u32 v237, v216, 4, s42
    s_lshl_b32 s42, s32, 7
    s_add_u32 s42, s42, 75264
    v_lshrrev_b32 v238, 3, v213
    v_lshl_add_u32 v238, v238, 4, s42
    v_and_b32 v219, 7, v213
    v_lshlrev_b32 v220, 1, v216
    v_xor_b32 v219, v219, v220
    v_xor_b32 v220, 0, v219
    v_lshlrev_b32 v200, 4, v220
    v_xor_b32 v220, 1, v219
    v_lshlrev_b32 v201, 4, v220
    v_xor_b32 v220, 4, v219
    v_lshlrev_b32 v202, 4, v220
    v_xor_b32 v220, 5, v219
    v_lshlrev_b32 v203, 4, v220
    s_and_b32 s42, s32, 3
    s_mul_i32 s42, s42, 24576
    v_mul_u32_u24 v239, 3072, v216
    v_add3_u32 v239, v239, v211, s42
    v_bfe_u32 v219, v213, 2, 2
    v_lshl_add_u32 v219, v216, 3, v219
    v_lshlrev_b32 v219, 7, v219
    v_bfe_u32 v220, v213, 4, 1
    v_lshl_add_u32 v219, v220, 5, v219
    v_and_b32 v220, 3, v213
    v_lshl_add_u32 v208, v220, 3, v219
    v_and_b32 v220, 8, v213
    v_lshl_add_u32 v208, v220, 3, v208
    s_cmp_lg_u32 s32, 1
    s_cbranch_scc1 L_POLL0_X
    s_mov_b32 s90, 0
    s_waitcnt vmcnt(0)
L_POLL0:
    v_readfirstlane_b32 s10, v178
    v_readfirstlane_b32 s11, v179
    s_xor_b32 s10, s10, 0x01010101
    s_xor_b32 s11, s11, 0x0101
    s_or_b32 s10, s10, s11
    s_cbranch_scc0 L_POLL0_X
    s_add_u32 s90, s90, 1
    s_cmp_gt_u32 s90, 0x80000
    s_cbranch_scc1 L_END
    s_sleep 8
    buffer_load_dwordx2 v[178:179], off, s[24:27], 0 sc1
    s_waitcnt vmcnt(0)
    s_branch L_POLL0
L_POLL0_X:
    s_waitcnt vmcnt(0)
    s_barrier
    v_lshlrev_b32 v216, 4, v213
    s_lshl_b32 s3, s58, 10
    s_cmp_eq_u32 s32, 0
    s_cselect_b64 exec, -1, 0
    buffer_store_dwordx4 v[224:227], v216, s[20:23], s3 offen sc1
    s_mov_b64 exec, -1
    v_lshlrev_b32 v215, 4, v212
    v_add_u32 v216, 8192, v215
    global_load_dwordx4 v[32:35], v216, s[100:101]
    global_load_dwordx4 v[36:39], v215, s[30:31]
    global_load_dwordx4 v[40:43], v215, s[100:101]
    global_load_dwordx4 v[44:47], v215, s[28:29]
    s_mul_i32 s43, s2, 12544
    buffer_load_dwordx4 v[48:51], v215, s[12:15], s43 offen
    s_add_u32 s43, s43, 8192
    s_movk_i32 s42, 272
    v_cmp_gt_u32 vcc, s42, v212
    s_nop 0
    s_and_saveexec_b64 s[84:85], vcc
    buffer_load_dwordx4 v[52:55], v215, s[12:15], s43 offen
    s_mov_b64 exec, s[84:85]
    v_and_b32 v221, 31, v213
    v_lshlrev_b32 v221, 1, v221
    v_add_u32 v221, 0x4000, v221
    global_load_ushort v192, v221, s[100:101] offset:0
    global_load_ushort v193, v221, s[100:101] offset:128
    global_load_ushort v194, v221, s[100:101] offset:256
    global_load_ushort v195, v221, s[100:101] offset:384
    global_load_ushort v196, v221, s[100:101] offset:64
    global_load_ushort v197, v221, s[100:101] offset:192
    global_load_ushort v198, v221, s[100:101] offset:320
    global_load_ushort v199, v221, s[100:101] offset:448
    s_mov_b32 s28, s76
    s_mov_b32 s29, s77
    s_mov_b32 s30, 0x30d400
    s_mov_b32 s31, 0x20000
    v_lshrrev_b32 v216, 3, v212
    v_mov_b32 v224, 0
    v_cmp_lt_u32 s[24:25], 62, v216
    s_mov_b64 s[4:5], 0
    v_mov_b32 v225, 0
    v_cmp_lt_u32 s[26:27], 62, v216
    s_mov_b64 s[6:7], 0
    v_mov_b32 v226, 0
    v_cmp_lt_u32 s[92:93], 61, v216
    s_mov_b64 s[96:97], 0
    v_mov_b32 v227, 0
    v_cmp_lt_u32 s[94:95], 61, v216
    s_mov_b64 s[98:99], 0
    s_mov_b32 s91, 0
    s_mov_b32 s40, 0
    v_lshlrev_b32 v214, 4, v212
    v_add_u32 v214, 75264, v214
    v_mov_b32 v184, 0
    v_mov_b32 v185, 0
    v_mov_b32 v186, 0
    v_mov_b32 v187, 0
    v_mov_b32 v188, 0x80000000
    v_mov_b32 v189, 0x80000000
    v_mov_b32 v190, 0x80000000
    v_mov_b32 v191, 0x80000000
    ds_write_b128 v214, v[188:191] offset:0
    s_movk_i32 s42, 504
    v_cmp_gt_u32 vcc, s42, v212
    s_nop 0
    s_and_saveexec_b64 s[84:85], vcc
    ds_write_b128 v214, v[188:191] offset:8192
    s_mov_b64 exec, s[84:85]
    ds_write_b128 v214, v[184:187] offset:16256
    ds_write_b128 v214, v[184:187] offset:24448
    ds_write_b128 v214, v[184:187] offset:32640
    ds_write_b128 v214, v[184:187] offset:40832
    s_movk_i32 s42, 238
    v_cmp_gt_u32 vcc, s42, v212
    s_nop 0
    s_and_saveexec_b64 s[84:85], vcc
    ds_write_b128 v214, v[184:187] offset:49024
    s_mov_b64 exec, s[84:85]
    v_lshlrev_b32 v215, 4, v212
    s_mov_b32 s10, 0xbfb8aa3b
    s_mov_b32 s11, 0xbfb8aa3b
    s_waitcnt vmcnt(13)
    v_lshlrev_b32 v56, 16, v32
    v_and_b32 v57, 0xffff0000, v32
    v_lshlrev_b32 v58, 16, v33
    v_and_b32 v59, 0xffff0000, v33
    v_lshlrev_b32 v60, 16, v34
    v_and_b32 v61, 0xffff0000, v34
    v_lshlrev_b32 v62, 16, v35
    v_and_b32 v63, 0xffff0000, v35
    v_pk_mul_f32 v[56:57], v[56:57], s[10:11]
    v_pk_mul_f32 v[58:59], v[58:59], s[10:11]
    v_pk_mul_f32 v[60:61], v[60:61], s[10:11]
    v_pk_mul_f32 v[62:63], v[62:63], s[10:11]
    v_cvt_pk_bf16_f32 v32, v56, v57
    v_cvt_pk_bf16_f32 v33, v58, v59
    v_cvt_pk_bf16_f32 v34, v60, v61
    v_cvt_pk_bf16_f32 v35, v62, v63
    v_and_b32 v216, 16, v212
    v_lshlrev_b32 v216, 2, v216
    v_xor_b32 v216, v216, v215
    v_add_u32 v216, 129136, v216
    ds_write_b128 v216, v[32:35] offset:0
    s_waitcnt vmcnt(12)
    ds_write_b128 v216, v[36:39] offset:8192
    s_waitcnt vmcnt(11)
    ds_write_b128 v216, v[40:43] offset:16384
    s_waitcnt vmcnt(10)
    ds_write_b128 v216, v[44:47] offset:24576
    v_lshrrev_b32 v216, 3, v212
    v_xor_b32 v217, v216, v212
    v_and_b32 v217, 7, v217
    v_and_b32 v218, 8, v216
    v_or_b32 v217, v217, v218
    v_mul_u32_u24 v216, 768, v216
    v_lshl_add_u32 v216, v217, 4, v216
    s_waitcnt vmcnt(9)
    ds_write_b128 v216, v[48:51] offset:0
    ds_write_b128 v216, v[48:51] offset:256
    s_movk_i32 s42, 272
    v_cmp_gt_u32 vcc, s42, v212
    s_nop 0
    s_and_saveexec_b64 s[84:85], vcc
    s_waitcnt vmcnt(8)
    ds_write_b128 v216, v[52:55] offset:49152
    ds_write_b128 v216, v[52:55] offset:49408
    s_mov_b64 exec, s[84:85]
    s_mov_b32 s10, 0xbfb8aa3b
    v_cmp_lt_u32 vcc, 31, v213
    s_waitcnt vmcnt(7)
    v_lshlrev_b32 v192, 16, v192
    v_mul_f32 v192, s10, v192
    s_waitcnt vmcnt(6)
    v_lshlrev_b32 v193, 16, v193
    v_mul_f32 v193, s10, v193
    s_waitcnt vmcnt(5)
    v_lshlrev_b32 v194, 16, v194
    v_mul_f32 v194, s10, v194
    s_waitcnt vmcnt(4)
    v_lshlrev_b32 v195, 16, v195
    v_mul_f32 v195, s10, v195
    s_waitcnt vmcnt(3)
    v_lshlrev_b32 v196, 16, v196
    v_mul_f32 v196, s10, v196
    s_waitcnt vmcnt(2)
    v_lshlrev_b32 v197, 16, v197
    v_mul_f32 v197, s10, v197
    s_waitcnt vmcnt(1)
    v_lshlrev_b32 v198, 16, v198
    v_mul_f32 v198, s10, v198
    s_waitcnt vmcnt(0)
    v_lshlrev_b32 v199, 16, v199
    v_mul_f32 v199, s10, v199
    v_mov_b32 v218, 0xc1f0
    v_cvt_pk_bf16_f32 v217, v192, v193
    v_cndmask_b32 v64, v217, v218, vcc
    v_cvt_pk_bf16_f32 v217, v194, v195
    v_cndmask_b32 v65, v217, 0, vcc
    v_cvt_pk_bf16_f32 v217, v196, v197
    v_cndmask_b32 v68, v217, v218, vcc
    v_cvt_pk_bf16_f32 v217, v198, v199
    v_cndmask_b32 v69, v217, 0, vcc
    v_and_b32 v216, 31, v213
    v_lshrrev_b32 v217, 5, v213
    v_and_b32 v218, 15, v216
    v_xor_b32 v218, v218, v217
    s_and_b32 s42, s32, 3
    s_mul_i32 s42, s42, 24576
    s_cmp_lt_u32 s32, 4
    s_cselect_b32 s3, 256, 0
    s_add_u32 s42, s42, s3
    v_mul_u32_u24 v216, 768, v216
    v_add_u32 v216, s42, v216
    v_xor_b32 v219, 0, v218
    v_lshl_add_u32 v192, v219, 4, v216
    v_xor_b32 v219, 2, v218
    v_lshl_add_u32 v193, v219, 4, v216
    v_xor_b32 v219, 4, v218
    v_lshl_add_u32 v194, v219, 4, v216
    v_xor_b32 v219, 6, v218
    v_lshl_add_u32 v195, v219, 4, v216
    s_cmp_lt_u32 s32, 4
    s_cselect_b32 s3, 8192, 0
    s_add_u32 s3, s3, 145520
    v_xor_b32 v216, 64, v208
    v_add_u32 v209, s3, v208
    v_add_u32 v210, 129136, v208
    v_add_u32 v196, s3, v216
    v_add_u32 v197, 129136, v216
    v_lshrrev_b32 v216, 3, v212
    v_lshlrev_b32 v216, 12, v216
    s_lshl_b32 s3, s2, 2
    s_andn2_b64 exec, -1, s[24:25]
    buffer_load_dword v224, v216, s[20:23], s3 offen offset:0 sc1
    s_andn2_b64 exec, -1, s[26:27]
    buffer_load_dword v225, v216, s[20:23], s3 offen offset:1024 sc1
    s_andn2_b64 exec, -1, s[92:93]
    buffer_load_dword v226, v216, s[20:23], s3 offen offset:2048 sc1
    s_andn2_b64 exec, -1, s[94:95]
    buffer_load_dword v227, v216, s[20:23], s3 offen offset:3072 sc1
    s_mov_b64 exec, -1
    s_waitcnt lgkmcnt(0)
    s_barrier
    ds_read_b128 v[76:79], v192
    ds_read_b128 v[80:83], v193
    ds_read_b128 v[84:87], v194
    ds_read_b128 v[88:91], v195
    ds_read_b64_tr_b16 v[0:1], v209 offset:0
    ds_read_b64_tr_b16 v[2:3], v209 offset:512
    ds_read_b64_tr_b16 v[4:5], v196 offset:0
    ds_read_b64_tr_b16 v[6:7], v196 offset:512
    ds_read_b64_tr_b16 v[8:9], v209 offset:2048
    ds_read_b64_tr_b16 v[10:11], v209 offset:2560
    ds_read_b64_tr_b16 v[12:13], v196 offset:2048
    ds_read_b64_tr_b16 v[14:15], v196 offset:2560
    ds_read_b64_tr_b16 v[16:17], v209 offset:4096
    ds_read_b64_tr_b16 v[18:19], v209 offset:4608
    ds_read_b64_tr_b16 v[20:21], v196 offset:4096
    ds_read_b64_tr_b16 v[22:23], v196 offset:4608
    ds_read_b64_tr_b16 v[24:25], v209 offset:6144
    ds_read_b64_tr_b16 v[26:27], v209 offset:6656
    ds_read_b64_tr_b16 v[28:29], v196 offset:6144
    ds_read_b64_tr_b16 v[30:31], v196 offset:6656
    v_mov_b32 v209, v197
    s_waitcnt lgkmcnt(14)
    v_mfma_f32_32x32x16_bf16 v[184:199], v[76:79], v[0:3], 0
    s_waitcnt lgkmcnt(10)
    v_mfma_f32_32x32x16_bf16 v[184:199], v[80:83], v[8:11], v[184:199]
    s_waitcnt lgkmcnt(6)
    v_mfma_f32_32x32x16_bf16 v[184:199], v[84:87], v[16:19], v[184:199]
    s_waitcnt lgkmcnt(2)
    v_mfma_f32_32x32x16_bf16 v[184:199], v[88:91], v[24:27], v[184:199]
    v_mfma_f32_32x32x16_bf16 v[240:255], v[76:79], v[4:7], 0
    v_mfma_f32_32x32x16_bf16 v[240:255], v[80:83], v[12:15], v[240:255]
    v_mfma_f32_32x32x16_bf16 v[240:255], v[84:87], v[20:23], v[240:255]
    s_waitcnt lgkmcnt(0)
    v_mfma_f32_32x32x16_bf16 v[240:255], v[88:91], v[28:31], v[240:255]
    s_nop 7
    s_waitcnt vmcnt(0)
    v_cmp_gt_i32 vcc, 0, v224
    s_nop 0
    s_andn2_b64 s[4:5], vcc, s[24:25]
    s_or_b64 s[24:25], s[24:25], vcc
    v_cmp_gt_i32 vcc, 0, v225
    s_nop 0
    s_andn2_b64 s[6:7], vcc, s[26:27]
    s_or_b64 s[26:27], s[26:27], vcc
    v_cmp_gt_i32 vcc, 0, v226
    s_nop 0
    s_andn2_b64 s[96:97], vcc, s[92:93]
    s_or_b64 s[92:93], s[92:93], vcc
    v_cmp_gt_i32 vcc, 0, v227
    s_nop 0
    s_andn2_b64 s[98:99], vcc, s[94:95]
    s_or_b64 s[94:95], s[94:95], vcc
    s_and_b64 s[84:85], s[24:25], s[26:27]
    s_and_b64 s[84:85], s[84:85], s[92:93]
    s_and_b64 s[84:85], s[84:85], s[94:95]
    s_cmp_eq_u64 s[84:85], -1
    s_cselect_b32 s91, 1, 0
    s_mul_i32 s3, s33, 12
    v_add_u32 v216, s33, v75
    v_sub_u32 v215, s34, v75
    v_and_b32 v217, 0xffff, v224
    v_mad_u32_u24 v228, v217, 12, v74
    v_bfe_u32 v232, v224, 16, 15
    v_sub_u32 v232, v232, v216
    v_and_b32 v217, 0xffff, v225
    v_mad_u32_u24 v229, v217, 12, v74
    v_bfe_u32 v233, v225, 16, 15
    v_sub_u32 v233, v233, v216
    v_and_b32 v217, 0xffff, v226
    v_mad_u32_u24 v230, v217, 12, v74
    v_bfe_u32 v234, v226, 16, 15
    v_sub_u32 v234, v234, v216
    v_and_b32 v217, 0xffff, v227
    v_mad_u32_u24 v231, v217, 12, v74
    v_bfe_u32 v235, v227, 16, 15
    v_sub_u32 v235, v235, v216
    v_max_i32 v217, v232, v233
    v_max3_i32 v217, v217, v234, v235
    v_min_i32 v232, v215, v232
    v_min_i32 v233, v215, v233
    v_min_i32 v234, v215, v234
    v_min_i32 v235, v215, v235
    v_cmp_lt_i32 s[44:45], 0, v232
    v_cmp_lt_i32 s[46:47], 0, v233
    v_cmp_lt_i32 s[48:49], 0, v234
    v_cmp_lt_i32 s[50:51], 0, v235
    v_cmp_lt_i32 s[86:87], v215, v217
    v_min_i32 v217, v215, v217
    s_add_u32 s43, s3, 0
    s_and_b64 exec, s[44:45], s[4:5]
    buffer_load_dwordx3 v[104:106], v228, s[16:19], s43 offen offset:0
    s_add_u32 s43, s3, 38528
    s_and_b64 exec, s[46:47], s[6:7]
    buffer_load_dwordx3 v[108:110], v229, s[16:19], s43 offen offset:0
    s_add_u32 s43, s3, 77056
    s_and_b64 exec, s[48:49], s[96:97]
    buffer_load_dwordx3 v[112:114], v230, s[16:19], s43 offen offset:0
    s_add_u32 s43, s3, 115584
    s_and_b64 exec, s[50:51], s[98:99]
    buffer_load_dwordx3 v[116:118], v231, s[16:19], s43 offen offset:0
    s_mov_b64 exec, -1
    v_cmp_lt_i32 s[52:53], 8, v232
    v_cmp_lt_i32 s[54:55], 8, v233
    v_cmp_lt_i32 s[56:57], 8, v234
    v_cmp_lt_i32 s[58:59], 8, v235
    v_cmp_lt_i32 vcc, 24, v217
    v_cmp_lt_i32 s[84:85], 32, v217
    s_add_u32 s43, s3, 0
    s_and_b64 exec, s[52:53], s[4:5]
    buffer_load_dwordx3 v[120:122], v228, s[16:19], s43 offen offset:96
    s_add_u32 s43, s3, 38528
    s_and_b64 exec, s[54:55], s[6:7]
    buffer_load_dwordx3 v[124:126], v229, s[16:19], s43 offen offset:96
    s_add_u32 s43, s3, 77056
    s_and_b64 exec, s[56:57], s[96:97]
    buffer_load_dwordx3 v[128:130], v230, s[16:19], s43 offen offset:96
    s_add_u32 s43, s3, 115584
    s_and_b64 exec, s[58:59], s[98:99]
    buffer_load_dwordx3 v[132:134], v231, s[16:19], s43 offen offset:96
    s_cmp_lg_u64 vcc, 0
    s_cselect_b32 s40, 1, 0
    s_cmp_lg_u64 s[84:85], 0
    s_cselect_b32 s40, 2, s40
    s_mov_b64 exec, -1
    v_cmp_lt_i32 s[60:61], 16, v232
    v_cmp_lt_i32 s[62:63], 16, v233
    v_cmp_lt_i32 s[64:65], 16, v234
    v_cmp_lt_i32 s[66:67], 16, v235
    s_add_u32 s43, s3, 0
    s_and_b64 exec, s[60:61], s[4:5]
    buffer_load_dwordx3 v[136:138], v228, s[16:19], s43 offen offset:192
    s_add_u32 s43, s3, 38528
    s_and_b64 exec, s[62:63], s[6:7]
    buffer_load_dwordx3 v[140:142], v229, s[16:19], s43 offen offset:192
    s_add_u32 s43, s3, 77056
    s_and_b64 exec, s[64:65], s[96:97]
    buffer_load_dwordx3 v[144:146], v230, s[16:19], s43 offen offset:192
    s_add_u32 s43, s3, 115584
    s_and_b64 exec, s[66:67], s[98:99]
    buffer_load_dwordx3 v[148:150], v231, s[16:19], s43 offen offset:192
    s_cmp_lt_u32 s40, 1
    s_cbranch_scc1 L_LR3_a
    s_mov_b64 exec, -1
    v_cmp_lt_i32 s[68:69], 24, v232
    v_cmp_lt_i32 s[70:71], 24, v233
    v_cmp_lt_i32 s[72:73], 24, v234
    v_cmp_lt_i32 s[74:75], 24, v235
    s_add_u32 s43, s3, 0
    s_and_b64 exec, s[68:69], s[4:5]
    buffer_load_dwordx3 v[152:154], v228, s[16:19], s43 offen offset:288
    s_add_u32 s43, s3, 38528
    s_and_b64 exec, s[70:71], s[6:7]
    buffer_load_dwordx3 v[156:158], v229, s[16:19], s43 offen offset:288
    s_add_u32 s43, s3, 77056
    s_and_b64 exec, s[72:73], s[96:97]
    buffer_load_dwordx3 v[160:162], v230, s[16:19], s43 offen offset:288
    s_add_u32 s43, s3, 115584
    s_and_b64 exec, s[74:75], s[98:99]
    buffer_load_dwordx3 v[164:166], v231, s[16:19], s43 offen offset:288
    s_cmp_lt_u32 s40, 2
    s_cbranch_scc1 L_LR3_a
    s_mov_b64 exec, -1
    v_cmp_lt_i32 s[76:77], 32, v232
    v_cmp_lt_i32 s[78:79], 32, v233
    v_cmp_lt_i32 s[80:81], 32, v234
    v_cmp_lt_i32 s[82:83], 32, v235
    s_add_u32 s43, s3, 0
    s_and_b64 exec, s[76:77], s[4:5]
    buffer_load_dwordx3 v[168:170], v228, s[16:19], s43 offen offset:384
    s_add_u32 s43, s3, 38528
    s_and_b64 exec, s[78:79], s[6:7]
    buffer_load_dwordx3 v[172:174], v229, s[16:19], s43 offen offset:384
    s_add_u32 s43, s3, 77056
    s_and_b64 exec, s[80:81], s[96:97]
    buffer_load_dwordx3 v[176:178], v230, s[16:19], s43 offen offset:384
    s_add_u32 s43, s3, 115584
    s_and_b64 exec, s[82:83], s[98:99]
    buffer_load_dwordx3 v[180:182], v231, s[16:19], s43 offen offset:384
L_LR3_a:
    s_mov_b64 exec, -1
    s_and_b32 s42, s32, 3
    s_cmp_eq_u32 s42, 3
    s_cselect_b32 s43, 1, 0
    s_cselect_b32 exec_hi, 0, -1
    s_cmp_lt_u32 s32, 4
    s_cbranch_scc1 L_UW
    s_mov_b32 s42, 0xbfb8aa3b
    v_mul_f32 v184, s42, v184
    v_mul_f32 v240, s42, v240
    v_cvt_pk_bf16_f32 v184, v184, v240
    ds_write_b32 v239, v184 offset:0
    v_mul_f32 v185, s42, v185
    v_mul_f32 v241, s42, v241
    v_cvt_pk_bf16_f32 v185, v185, v241
    ds_write_b32 v239, v185 offset:768
    s_cmp_eq_u32 s43, 1
    s_cbranch_scc1 L_NW
    v_mul_f32 v186, s42, v186
    v_mul_f32 v242, s42, v242
    v_cvt_pk_bf16_f32 v186, v186, v242
    ds_write_b32 v239, v186 offset:1536
    v_mul_f32 v187, s42, v187
    v_mul_f32 v243, s42, v243
    v_cvt_pk_bf16_f32 v187, v187, v243
    ds_write_b32 v239, v187 offset:2304
    v_mul_f32 v188, s42, v188
    v_mul_f32 v244, s42, v244
    v_cvt_pk_bf16_f32 v188, v188, v244
    ds_write_b32 v239, v188 offset:6144
    v_mul_f32 v189, s42, v189
    v_mul_f32 v245, s42, v245
    v_cvt_pk_bf16_f32 v189, v189, v245
    ds_write_b32 v239, v189 offset:6912
    v_mul_f32 v190, s42, v190
    v_mul_f32 v246, s42, v246
    v_cvt_pk_bf16_f32 v190, v190, v246
    ds_write_b32 v239, v190 offset:7680
    v_mul_f32 v191, s42, v191
    v_mul_f32 v247, s42, v247
    v_cvt_pk_bf16_f32 v191, v191, v247
    ds_write_b32 v239, v191 offset:8448
    v_mul_f32 v192, s42, v192
    v_mul_f32 v248, s42, v248
    v_cvt_pk_bf16_f32 v192, v192, v248
    ds_write_b32 v239, v192 offset:12288
    v_mul_f32 v193, s42, v193
    v_mul_f32 v249, s42, v249
    v_cvt_pk_bf16_f32 v193, v193, v249
    ds_write_b32 v239, v193 offset:13056
    v_mul_f32 v194, s42, v194
    v_mul_f32 v250, s42, v250
    v_cvt_pk_bf16_f32 v194, v194, v250
    ds_write_b32 v239, v194 offset:13824
    v_mul_f32 v195, s42, v195
    v_mul_f32 v251, s42, v251
    v_cvt_pk_bf16_f32 v195, v195, v251
    ds_write_b32 v239, v195 offset:14592
    v_mul_f32 v196, s42, v196
    v_mul_f32 v252, s42, v252
    v_cvt_pk_bf16_f32 v196, v196, v252
    ds_write_b32 v239, v196 offset:18432
    v_mul_f32 v197, s42, v197
    v_mul_f32 v253, s42, v253
    v_cvt_pk_bf16_f32 v197, v197, v253
    ds_write_b32 v239, v197 offset:19200
    v_mul_f32 v198, s42, v198
    v_mul_f32 v254, s42, v254
    v_cvt_pk_bf16_f32 v198, v198, v254
    ds_write_b32 v239, v198 offset:19968
    v_mul_f32 v199, s42, v199
    v_mul_f32 v255, s42, v255
    v_cvt_pk_bf16_f32 v199, v199, v255
    ds_write_b32 v239, v199 offset:20736
    s_branch L_NW
L_UW:
    s_mov_b32 s42, 0x4e800000
    v_mul_f32 v184, s42, v184
    v_cvt_f64_f32 v[96:97], v184
    ds_write_b64 v239, v[96:97] offset:256
    v_mul_f32 v240, s42, v240
    v_cvt_f64_f32 v[98:99], v240
    ds_write_b64 v239, v[98:99] offset:512
    v_mul_f32 v185, s42, v185
    v_cvt_f64_f32 v[100:101], v185
    ds_write_b64 v239, v[100:101] offset:1024
    v_mul_f32 v241, s42, v241
    v_cvt_f64_f32 v[102:103], v241
    ds_write_b64 v239, v[102:103] offset:1280
    s_cmp_eq_u32 s43, 1
    s_cbranch_scc1 L_NW
    v_mul_f32 v186, s42, v186
    v_cvt_f64_f32 v[96:97], v186
    ds_write_b64 v239, v[96:97] offset:1792
    v_mul_f32 v242, s42, v242
    v_cvt_f64_f32 v[98:99], v242
    ds_write_b64 v239, v[98:99] offset:2048
    v_mul_f32 v187, s42, v187
    v_cvt_f64_f32 v[100:101], v187
    ds_write_b64 v239, v[100:101] offset:2560
    v_mul_f32 v243, s42, v243
    v_cvt_f64_f32 v[102:103], v243
    ds_write_b64 v239, v[102:103] offset:2816
    v_mul_f32 v188, s42, v188
    v_cvt_f64_f32 v[96:97], v188
    ds_write_b64 v239, v[96:97] offset:6400
    v_mul_f32 v244, s42, v244
    v_cvt_f64_f32 v[98:99], v244
    ds_write_b64 v239, v[98:99] offset:6656
    v_mul_f32 v189, s42, v189
    v_cvt_f64_f32 v[100:101], v189
    ds_write_b64 v239, v[100:101] offset:7168
    v_mul_f32 v245, s42, v245
    v_cvt_f64_f32 v[102:103], v245
    ds_write_b64 v239, v[102:103] offset:7424
    v_mul_f32 v190, s42, v190
    v_cvt_f64_f32 v[96:97], v190
    ds_write_b64 v239, v[96:97] offset:7936
    v_mul_f32 v246, s42, v246
    v_cvt_f64_f32 v[98:99], v246
    ds_write_b64 v239, v[98:99] offset:8192
    v_mul_f32 v191, s42, v191
    v_cvt_f64_f32 v[100:101], v191
    ds_write_b64 v239, v[100:101] offset:8704
    v_mul_f32 v247, s42, v247
    v_cvt_f64_f32 v[102:103], v247
    ds_write_b64 v239, v[102:103] offset:8960
    v_mul_f32 v192, s42, v192
    v_cvt_f64_f32 v[96:97], v192
    ds_write_b64 v239, v[96:97] offset:12544
    v_mul_f32 v248, s42, v248
    v_cvt_f64_f32 v[98:99], v248
    ds_write_b64 v239, v[98:99] offset:12800
    v_mul_f32 v193, s42, v193
    v_cvt_f64_f32 v[100:101], v193
    ds_write_b64 v239, v[100:101] offset:13312
    v_mul_f32 v249, s42, v249
    v_cvt_f64_f32 v[102:103], v249
    ds_write_b64 v239, v[102:103] offset:13568
    v_mul_f32 v194, s42, v194
    v_cvt_f64_f32 v[96:97], v194
    ds_write_b64 v239, v[96:97] offset:14080
    v_mul_f32 v250, s42, v250
    v_cvt_f64_f32 v[98:99], v250
    ds_write_b64 v239, v[98:99] offset:14336
    v_mul_f32 v195, s42, v195
    v_cvt_f64_f32 v[100:101], v195
    ds_write_b64 v239, v[100:101] offset:14848
    v_mul_f32 v251, s42, v251
    v_cvt_f64_f32 v[102:103], v251
    ds_write_b64 v239, v[102:103] offset:15104
    v_mul_f32 v196, s42, v196
    v_cvt_f64_f32 v[96:97], v196
    ds_write_b64 v239, v[96:97] offset:18688
    v_mul_f32 v252, s42, v252
    v_cvt_f64_f32 v[98:99], v252
    ds_write_b64 v239, v[98:99] offset:18944
    v_mul_f32 v197, s42, v197
    v_cvt_f64_f32 v[100:101], v197
    ds_write_b64 v239, v[100:101] offset:19456
    v_mul_f32 v253, s42, v253
    v_cvt_f64_f32 v[102:103], v253
    ds_write_b64 v239, v[102:103] offset:19712
    v_mul_f32 v198, s42, v198
    v_cvt_f64_f32 v[96:97], v198
    ds_write_b64 v239, v[96:97] offset:20224
    v_mul_f32 v254, s42, v254
    v_cvt_f64_f32 v[98:99], v254
    ds_write_b64 v239, v[98:99] offset:20480
    v_mul_f32 v199, s42, v199
    v_cvt_f64_f32 v[100:101], v199
    ds_write_b64 v239, v[100:101] offset:20992
    v_mul_f32 v255, s42, v255
    v_cvt_f64_f32 v[102:103], v255
    ds_write_b64 v239, v[102:103] offset:21248
L_NW:
    s_mov_b64 exec, -1
    ds_read_b64_tr_b16 v[0:1], v210 offset:0
    ds_read_b64_tr_b16 v[2:3], v210 offset:512
    ds_read_b64_tr_b16 v[4:5], v209 offset:0
    ds_read_b64_tr_b16 v[6:7], v209 offset:512
    ds_read_b64_tr_b16 v[8:9], v210 offset:2048
    ds_read_b64_tr_b16 v[10:11], v210 offset:2560
    ds_read_b64_tr_b16 v[12:13], v209 offset:2048
    ds_read_b64_tr_b16 v[14:15], v209 offset:2560
    ds_read_b64_tr_b16 v[16:17], v210 offset:4096
    ds_read_b64_tr_b16 v[18:19], v210 offset:4608
    ds_read_b64_tr_b16 v[20:21], v209 offset:4096
    ds_read_b64_tr_b16 v[22:23], v209 offset:4608
    ds_read_b64_tr_b16 v[24:25], v210 offset:6144
    ds_read_b64_tr_b16 v[26:27], v210 offset:6656
    ds_read_b64_tr_b16 v[28:29], v209 offset:6144
    ds_read_b64_tr_b16 v[30:31], v209 offset:6656
    ds_read_b64_tr_b16 v[32:33], v210 offset:8192
    ds_read_b64_tr_b16 v[34:35], v210 offset:8704
    ds_read_b64_tr_b16 v[36:37], v209 offset:8192
    ds_read_b64_tr_b16 v[38:39], v209 offset:8704
    ds_read_b64_tr_b16 v[40:41], v210 offset:10240
    ds_read_b64_tr_b16 v[42:43], v210 offset:10752
    ds_read_b64_tr_b16 v[44:45], v209 offset:10240
    ds_read_b64_tr_b16 v[46:47], v209 offset:10752
    ds_read_b64_tr_b16 v[48:49], v210 offset:12288
    ds_read_b64_tr_b16 v[50:51], v210 offset:12800
    ds_read_b64_tr_b16 v[52:53], v209 offset:12288
    ds_read_b64_tr_b16 v[54:55], v209 offset:12800
    ds_read_b64_tr_b16 v[56:57], v210 offset:14336
    ds_read_b64_tr_b16 v[58:59], v210 offset:14848
    ds_read_b64_tr_b16 v[60:61], v209 offset:14336
    ds_read_b64_tr_b16 v[62:63], v209 offset:14848
    s_mov_b32 s90, 0
    s_waitcnt lgkmcnt(0)
L_PL:
    s_cmp_eq_u32 s91, 1
    s_cbranch_scc1 L_SORTW
    s_add_u32 s90, s90, 1
    s_cmp_gt_u32 s90, 0x80000
    s_cbranch_scc1 L_END
    s_or_b64 s[84:85], s[4:5], s[6:7]
    s_or_b64 s[84:85], s[84:85], s[96:97]
    s_or_b64 s[84:85], s[84:85], s[98:99]
    s_cbranch_scc1 L_NOSLP
    s_sleep 12
L_NOSLP:
    v_lshrrev_b32 v216, 3, v212
    v_lshlrev_b32 v216, 12, v216
    s_lshl_b32 s3, s2, 2
    s_andn2_b64 exec, -1, s[24:25]
    buffer_load_dword v224, v216, s[20:23], s3 offen offset:0 sc1
    s_andn2_b64 exec, -1, s[26:27]
    buffer_load_dword v225, v216, s[20:23], s3 offen offset:1024 sc1
    s_andn2_b64 exec, -1, s[92:93]
    buffer_load_dword v226, v216, s[20:23], s3 offen offset:2048 sc1
    s_andn2_b64 exec, -1, s[94:95]
    buffer_load_dword v227, v216, s[20:23], s3 offen offset:3072 sc1
    s_mov_b64 exec, -1
L_SORTW:
    s_waitcnt vmcnt(0)
    v_mov_b32 v214, 1
    s_and_b64 exec, s[44:45], s[4:5]
    v_lshrrev_b32 v76, 23, v106
    v_add_u32 v76, 128096, v76
    ds_add_rtn_u32 v107, v76, v214
    s_and_b64 exec, s[46:47], s[6:7]
    v_lshrrev_b32 v77, 23, v110
    v_add_u32 v77, 128096, v77
    ds_add_rtn_u32 v111, v77, v214
    s_and_b64 exec, s[48:49], s[96:97]
    v_lshrrev_b32 v78, 23, v114
    v_add_u32 v78, 128096, v78
    ds_add_rtn_u32 v115, v78, v214
    s_and_b64 exec, s[50:51], s[98:99]
    v_lshrrev_b32 v79, 23, v118
    v_add_u32 v79, 128096, v79
    ds_add_rtn_u32 v119, v79, v214
    s_and_b64 exec, s[52:53], s[4:5]
    v_lshrrev_b32 v80, 23, v122
    v_add_u32 v80, 128096, v80
    ds_add_rtn_u32 v123, v80, v214
    s_and_b64 exec, s[54:55], s[6:7]
    v_lshrrev_b32 v81, 23, v126
    v_add_u32 v81, 128096, v81
    ds_add_rtn_u32 v127, v81, v214
    s_and_b64 exec, s[56:57], s[96:97]
    v_lshrrev_b32 v82, 23, v130
    v_add_u32 v82, 128096, v82
    ds_add_rtn_u32 v131, v82, v214
    s_and_b64 exec, s[58:59], s[98:99]
    v_lshrrev_b32 v83, 23, v134
    v_add_u32 v83, 128096, v83
    ds_add_rtn_u32 v135, v83, v214
    s_and_b64 exec, s[60:61], s[4:5]
    v_lshrrev_b32 v84, 23, v138
    v_add_u32 v84, 128096, v84
    ds_add_rtn_u32 v139, v84, v214
    s_and_b64 exec, s[62:63], s[6:7]
    v_lshrrev_b32 v85, 23, v142
    v_add_u32 v85, 128096, v85
    ds_add_rtn_u32 v143, v85, v214
    s_and_b64 exec, s[64:65], s[96:97]
    v_lshrrev_b32 v86, 23, v146
    v_add_u32 v86, 128096, v86
    ds_add_rtn_u32 v147, v86, v214
    s_and_b64 exec, s[66:67], s[98:99]
    v_lshrrev_b32 v87, 23, v150
    v_add_u32 v87, 128096, v87
    ds_add_rtn_u32 v151, v87, v214
    s_cmp_lt_u32 s40, 1
    s_cbranch_scc1 L_AT3
    s_and_b64 exec, s[68:69], s[4:5]
    v_lshrrev_b32 v88, 23, v154
    v_add_u32 v88, 128096, v88
    ds_add_rtn_u32 v155, v88, v214
    s_and_b64 exec, s[70:71], s[6:7]
    v_lshrrev_b32 v89, 23, v158
    v_add_u32 v89, 128096, v89
    ds_add_rtn_u32 v159, v89, v214
    s_and_b64 exec, s[72:73], s[96:97]
    v_lshrrev_b32 v90, 23, v162
    v_add_u32 v90, 128096, v90
    ds_add_rtn_u32 v163, v90, v214
    s_and_b64 exec, s[74:75], s[98:99]
    v_lshrrev_b32 v91, 23, v166
    v_add_u32 v91, 128096, v91
    ds_add_rtn_u32 v167, v91, v214
    s_cmp_lt_u32 s40, 2
    s_cbranch_scc1 L_AT3
    s_and_b64 exec, s[76:77], s[4:5]
    v_lshrrev_b32 v96, 23, v170
    v_add_u32 v96, 128096, v96
    ds_add_rtn_u32 v171, v96, v214
    s_and_b64 exec, s[78:79], s[6:7]
    v_lshrrev_b32 v97, 23, v174
    v_add_u32 v97, 128096, v97
    ds_add_rtn_u32 v175, v97, v214
    s_and_b64 exec, s[80:81], s[96:97]
    v_lshrrev_b32 v98, 23, v178
    v_add_u32 v98, 128096, v98
    ds_add_rtn_u32 v179, v98, v214
    s_and_b64 exec, s[82:83], s[98:99]
    v_lshrrev_b32 v99, 23, v182
    v_add_u32 v99, 128096, v99
    ds_add_rtn_u32 v183, v99, v214
L_AT3:
    s_mov_b64 exec, -1
    s_cmp_eq_u32 s91, 1
    s_cbranch_scc1 L_SORT2
    v_cmp_gt_i32 vcc, 0, v224
    s_nop 0
    s_andn2_b64 s[4:5], vcc, s[24:25]
    s_or_b64 s[24:25], s[24:25], vcc
    v_cmp_gt_i32 vcc, 0, v225
    s_nop 0
    s_andn2_b64 s[6:7], vcc, s[26:27]
    s_or_b64 s[26:27], s[26:27], vcc
    v_cmp_gt_i32 vcc, 0, v226
    s_nop 0
    s_andn2_b64 s[96:97], vcc, s[92:93]
    s_or_b64 s[92:93], s[92:93], vcc
    v_cmp_gt_i32 vcc, 0, v227
    s_nop 0
    s_andn2_b64 s[98:99], vcc, s[94:95]
    s_or_b64 s[94:95], s[94:95], vcc
    s_and_b64 s[84:85], s[24:25], s[26:27]
    s_and_b64 s[84:85], s[84:85], s[92:93]
    s_and_b64 s[84:85], s[84:85], s[94:95]
    s_cmp_eq_u64 s[84:85], -1
    s_cselect_b32 s91, 1, 0
    s_mul_i32 s3, s33, 12
    v_add_u32 v216, s33, v75
    v_sub_u32 v215, s34, v75
    v_and_b32 v217, 0xffff, v224
    v_mad_u32_u24 v228, v217, 12, v74
    v_bfe_u32 v232, v224, 16, 15
    v_sub_u32 v232, v232, v216
    v_and_b32 v217, 0xffff, v225
    v_mad_u32_u24 v229, v217, 12, v74
    v_bfe_u32 v233, v225, 16, 15
    v_sub_u32 v233, v233, v216
    v_and_b32 v217, 0xffff, v226
    v_mad_u32_u24 v230, v217, 12, v74
    v_bfe_u32 v234, v226, 16, 15
    v_sub_u32 v234, v234, v216
    v_and_b32 v217, 0xffff, v227
    v_mad_u32_u24 v231, v217, 12, v74
    v_bfe_u32 v235, v227, 16, 15
    v_sub_u32 v235, v235, v216
    v_max_i32 v217, v232, v233
    v_max3_i32 v217, v217, v234, v235
    v_min_i32 v232, v215, v232
    v_min_i32 v233, v215, v233
    v_min_i32 v234, v215, v234
    v_min_i32 v235, v215, v235
    v_cmp_lt_i32 s[44:45], 0, v232
    v_cmp_lt_i32 s[46:47], 0, v233
    v_cmp_lt_i32 s[48:49], 0, v234
    v_cmp_lt_i32 s[50:51], 0, v235
    v_cmp_lt_i32 s[86:87], v215, v217
    v_min_i32 v217, v215, v217
    s_add_u32 s43, s3, 0
    s_and_b64 exec, s[44:45], s[4:5]
    buffer_load_dwordx3 v[104:106], v228, s[16:19], s43 offen offset:0
    s_add_u32 s43, s3, 38528
    s_and_b64 exec, s[46:47], s[6:7]
    buffer_load_dwordx3 v[108:110], v229, s[16:19], s43 offen offset:0
    s_add_u32 s43, s3, 77056
    s_and_b64 exec, s[48:49], s[96:97]
    buffer_load_dwordx3 v[112:114], v230, s[16:19], s43 offen offset:0
    s_add_u32 s43, s3, 115584
    s_and_b64 exec, s[50:51], s[98:99]
    buffer_load_dwordx3 v[116:118], v231, s[16:19], s43 offen offset:0
    s_mov_b64 exec, -1
    v_cmp_lt_i32 s[52:53], 8, v232
    v_cmp_lt_i32 s[54:55], 8, v233
    v_cmp_lt_i32 s[56:57], 8, v234
    v_cmp_lt_i32 s[58:59], 8, v235
    v_cmp_lt_i32 vcc, 24, v217
    v_cmp_lt_i32 s[84:85], 32, v217
    s_add_u32 s43, s3, 0
    s_and_b64 exec, s[52:53], s[4:5]
    buffer_load_dwordx3 v[120:122], v228, s[16:19], s43 offen offset:96
    s_add_u32 s43, s3, 38528
    s_and_b64 exec, s[54:55], s[6:7]
    buffer_load_dwordx3 v[124:126], v229, s[16:19], s43 offen offset:96
    s_add_u32 s43, s3, 77056
    s_and_b64 exec, s[56:57], s[96:97]
    buffer_load_dwordx3 v[128:130], v230, s[16:19], s43 offen offset:96
    s_add_u32 s43, s3, 115584
    s_and_b64 exec, s[58:59], s[98:99]
    buffer_load_dwordx3 v[132:134], v231, s[16:19], s43 offen offset:96
    s_cmp_lg_u64 vcc, 0
    s_cselect_b32 s40, 1, 0
    s_cmp_lg_u64 s[84:85], 0
    s_cselect_b32 s40, 2, s40
    s_mov_b64 exec, -1
    v_cmp_lt_i32 s[60:61], 16, v232
    v_cmp_lt_i32 s[62:63], 16, v233
    v_cmp_lt_i32 s[64:65], 16, v234
    v_cmp_lt_i32 s[66:67], 16, v235
    s_add_u32 s43, s3, 0
    s_and_b64 exec, s[60:61], s[4:5]
    buffer_load_dwordx3 v[136:138], v228, s[16:19], s43 offen offset:192
    s_add_u32 s43, s3, 38528
    s_and_b64 exec, s[62:63], s[6:7]
    buffer_load_dwordx3 v[140:142], v229, s[16:19], s43 offen offset:192
    s_add_u32 s43, s3, 77056
    s_and_b64 exec, s[64:65], s[96:97]
    buffer_load_dwordx3 v[144:146], v230, s[16:19], s43 offen offset:192
    s_add_u32 s43, s3, 115584
    s_and_b64 exec, s[66:67], s[98:99]
    buffer_load_dwordx3 v[148:150], v231, s[16:19], s43 offen offset:192
    s_cmp_lt_u32 s40, 1
    s_cbranch_scc1 L_LR3_c
    s_mov_b64 exec, -1
    v_cmp_lt_i32 s[68:69], 24, v232
    v_cmp_lt_i32 s[70:71], 24, v233
    v_cmp_lt_i32 s[72:73], 24, v234
    v_cmp_lt_i32 s[74:75], 24, v235
    s_add_u32 s43, s3, 0
    s_and_b64 exec, s[68:69], s[4:5]
    buffer_load_dwordx3 v[152:154], v228, s[16:19], s43 offen offset:288
    s_add_u32 s43, s3, 38528
    s_and_b64 exec, s[70:71], s[6:7]
    buffer_load_dwordx3 v[156:158], v229, s[16:19], s43 offen offset:288
    s_add_u32 s43, s3, 77056
    s_and_b64 exec, s[72:73], s[96:97]
    buffer_load_dwordx3 v[160:162], v230, s[16:19], s43 offen offset:288
    s_add_u32 s43, s3, 115584
    s_and_b64 exec, s[74:75], s[98:99]
    buffer_load_dwordx3 v[164:166], v231, s[16:19], s43 offen offset:288
    s_cmp_lt_u32 s40, 2
    s_cbranch_scc1 L_LR3_c
    s_mov_b64 exec, -1
    v_cmp_lt_i32 s[76:77], 32, v232
    v_cmp_lt_i32 s[78:79], 32, v233
    v_cmp_lt_i32 s[80:81], 32, v234
    v_cmp_lt_i32 s[82:83], 32, v235
    s_add_u32 s43, s3, 0
    s_and_b64 exec, s[76:77], s[4:5]
    buffer_load_dwordx3 v[168:170], v228, s[16:19], s43 offen offset:384
    s_add_u32 s43, s3, 38528
    s_and_b64 exec, s[78:79], s[6:7]
    buffer_load_dwordx3 v[172:174], v229, s[16:19], s43 offen offset:384
    s_add_u32 s43, s3, 77056
    s_and_b64 exec, s[80:81], s[96:97]
    buffer_load_dwordx3 v[176:178], v230, s[16:19], s43 offen offset:384
    s_add_u32 s43, s3, 115584
    s_and_b64 exec, s[82:83], s[98:99]
    buffer_load_dwordx3 v[180:182], v231, s[16:19], s43 offen offset:384
L_LR3_c:
    s_mov_b64 exec, -1
    s_waitcnt lgkmcnt(0)
    s_branch L_PL
L_SORT2:
    v_mov_b32 v215, 128608
    s_mov_b64 exec, s[86:87]
    ds_write_b32 v215, v214
    s_mov_b64 exec, -1
    v_lshlrev_b32 v216, 3, v213
    v_add_u32 v216, 128096, v216
    s_waitcnt lgkmcnt(0)
    s_barrier
    ds_read_b64 v[218:219], v216
    ds_read_b32 v217, v215
    s_waitcnt lgkmcnt(1)
    v_add_u32 v218, 3, v218
    v_and_b32 v218, -4, v218
    v_add_u32 v219, 3, v219
    v_and_b32 v219, -4, v219
    v_add_u32 v220, v218, v219
    s_nop 1
    v_add_u32_dpp v220, v220, v220 row_shr:1 row_mask:0xf bank_mask:0xf bound_ctrl:0
    s_nop 1
    v_add_u32_dpp v220, v220, v220 row_shr:2 row_mask:0xf bank_mask:0xf bound_ctrl:0
    s_nop 1
    v_add_u32_dpp v220, v220, v220 row_shr:4 row_mask:0xf bank_mask:0xf bound_ctrl:0
    s_nop 1
    v_add_u32_dpp v220, v220, v220 row_shr:8 row_mask:0xf bank_mask:0xf bound_ctrl:0
    s_nop 1
    v_add_u32_dpp v220, v220, v220 row_bcast:15 row_mask:0xa bank_mask:0xf
    s_nop 1
    v_add_u32_dpp v220, v220, v220 row_bcast:31 row_mask:0xc bank_mask:0xf
    v_add_u32 v223, 124032, v220
    v_sub_u32 v223, v223, v219
    v_sub_u32 v222, v223, v218
    ds_write_b64 v216, v[222:223] offset:528
    v_readlane_b32 s41, v220, 63
    s_waitcnt lgkmcnt(1)
    v_readfirstlane_b32 s86, v217
    s_cmp_gt_u32 s41, 4064
    s_cbranch_scc1 L_SLOW
    s_add_u32 s41, s41, 31
    s_lshr_b32 s41, s41, 5
    s_waitcnt lgkmcnt(0)
    s_mov_b64 exec, s[44:45]
    ds_read_b32 v76, v76 offset:528
    s_mov_b64 exec, s[46:47]
    ds_read_b32 v77, v77 offset:528
    s_mov_b64 exec, s[48:49]
    ds_read_b32 v78, v78 offset:528
    s_mov_b64 exec, s[50:51]
    ds_read_b32 v79, v79 offset:528
    s_mov_b64 exec, s[52:53]
    ds_read_b32 v80, v80 offset:528
    s_mov_b64 exec, s[54:55]
    ds_read_b32 v81, v81 offset:528
    s_mov_b64 exec, s[56:57]
    ds_read_b32 v82, v82 offset:528
    s_mov_b64 exec, s[58:59]
    ds_read_b32 v83, v83 offset:528
    s_mov_b64 exec, s[60:61]
    ds_read_b32 v84, v84 offset:528
    s_mov_b64 exec, s[62:63]
    ds_read_b32 v85, v85 offset:528
    s_mov_b64 exec, s[64:65]
    ds_read_b32 v86, v86 offset:528
    s_mov_b64 exec, s[66:67]
    ds_read_b32 v87, v87 offset:528
    s_cmp_lt_u32 s40, 1
    s_cbranch_scc1 L_SR3
    s_mov_b64 exec, s[68:69]
    ds_read_b32 v88, v88 offset:528
    s_mov_b64 exec, s[70:71]
    ds_read_b32 v89, v89 offset:528
    s_mov_b64 exec, s[72:73]
    ds_read_b32 v90, v90 offset:528
    s_mov_b64 exec, s[74:75]
    ds_read_b32 v91, v91 offset:528
    s_cmp_lt_u32 s40, 2
    s_cbranch_scc1 L_SR3
    s_mov_b64 exec, s[76:77]
    ds_read_b32 v96, v96 offset:528
    s_mov_b64 exec, s[78:79]
    ds_read_b32 v97, v97 offset:528
    s_mov_b64 exec, s[80:81]
    ds_read_b32 v98, v98 offset:528
    s_mov_b64 exec, s[82:83]
    ds_read_b32 v99, v99 offset:528
L_SR3:
    s_mov_b64 exec, -1
    s_mov_b32 s42, 0x3fffff
    s_mov_b32 s10, 0xfff99400
    s_mov_b32 s11, 0xfff24180
    v_mov_b32 v208, v238
    v_mov_b32 v209, v236
    v_mov_b32 v210, v237
    s_sub_u32 s35, s41, s32
    s_add_u32 s35, s35, 7
    s_ashr_i32 s35, s35, 3
    s_waitcnt lgkmcnt(0)
    s_mov_b64 exec, s[44:45]
    v_add_u32 v76, v76, v107
    v_and_b32 v106, s42, v106
    v_lshl_add_u32 v107, v76, 2, s10
    ds_write_b32 v107, v106
    s_mov_b64 exec, s[46:47]
    v_add_u32 v77, v77, v111
    v_and_b32 v110, s42, v110
    v_lshl_add_u32 v111, v77, 2, s10
    ds_write_b32 v111, v110
    s_mov_b64 exec, s[48:49]
    v_add_u32 v78, v78, v115
    v_and_b32 v114, s42, v114
    v_lshl_add_u32 v115, v78, 2, s10
    ds_write_b32 v115, v114
    s_mov_b64 exec, s[50:51]
    v_add_u32 v79, v79, v119
    v_and_b32 v118, s42, v118
    v_lshl_add_u32 v119, v79, 2, s10
    ds_write_b32 v119, v118
    s_mov_b64 exec, s[52:53]
    v_add_u32 v80, v80, v123
    v_and_b32 v122, s42, v122
    v_lshl_add_u32 v123, v80, 2, s10
    ds_write_b32 v123, v122
    s_mov_b64 exec, s[54:55]
    v_add_u32 v81, v81, v127
    v_and_b32 v126, s42, v126
    v_lshl_add_u32 v127, v81, 2, s10
    ds_write_b32 v127, v126
    s_mov_b64 exec, s[56:57]
    v_add_u32 v82, v82, v131
    v_and_b32 v130, s42, v130
    v_lshl_add_u32 v131, v82, 2, s10
    ds_write_b32 v131, v130
    s_mov_b64 exec, s[58:59]
    v_add_u32 v83, v83, v135
    v_and_b32 v134, s42, v134
    v_lshl_add_u32 v135, v83, 2, s10
    ds_write_b32 v135, v134
    s_mov_b64 exec, s[60:61]
    v_add_u32 v84, v84, v139
    v_and_b32 v138, s42, v138
    v_lshl_add_u32 v139, v84, 2, s10
    ds_write_b32 v139, v138
    s_mov_b64 exec, s[62:63]
    v_add_u32 v85, v85, v143
    v_and_b32 v142, s42, v142
    v_lshl_add_u32 v143, v85, 2, s10
    ds_write_b32 v143, v142
    s_mov_b64 exec, s[64:65]
    v_add_u32 v86, v86, v147
    v_and_b32 v146, s42, v146
    v_lshl_add_u32 v147, v86, 2, s10
    ds_write_b32 v147, v146
    s_mov_b64 exec, s[66:67]
    v_add_u32 v87, v87, v151
    v_and_b32 v150, s42, v150
    v_lshl_add_u32 v151, v87, 2, s10
    ds_write_b32 v151, v150
    s_cmp_lt_u32 s40, 1
    s_cbranch_scc1 L_SC3
    s_mov_b64 exec, s[68:69]
    v_add_u32 v88, v88, v155
    v_and_b32 v154, s42, v154
    v_lshl_add_u32 v155, v88, 2, s10
    ds_write_b32 v155, v154
    s_mov_b64 exec, s[70:71]
    v_add_u32 v89, v89, v159
    v_and_b32 v158, s42, v158
    v_lshl_add_u32 v159, v89, 2, s10
    ds_write_b32 v159, v158
    s_mov_b64 exec, s[72:73]
    v_add_u32 v90, v90, v163
    v_and_b32 v162, s42, v162
    v_lshl_add_u32 v163, v90, 2, s10
    ds_write_b32 v163, v162
    s_mov_b64 exec, s[74:75]
    v_add_u32 v91, v91, v167
    v_and_b32 v166, s42, v166
    v_lshl_add_u32 v167, v91, 2, s10
    ds_write_b32 v167, v166
    s_cmp_lt_u32 s40, 2
    s_cbranch_scc1 L_SC3
    s_mov_b64 exec, s[76:77]
    v_add_u32 v96, v96, v171
    v_and_b32 v170, s42, v170
    v_lshl_add_u32 v171, v96, 2, s10
    ds_write_b32 v171, v170
    s_mov_b64 exec, s[78:79]
    v_add_u32 v97, v97, v175
    v_and_b32 v174, s42, v174
    v_lshl_add_u32 v175, v97, 2, s10
    ds_write_b32 v175, v174
    s_mov_b64 exec, s[80:81]
    v_add_u32 v98, v98, v179
    v_and_b32 v178, s42, v178
    v_lshl_add_u32 v179, v98, 2, s10
    ds_write_b32 v179, v178
    s_mov_b64 exec, s[82:83]
    v_add_u32 v99, v99, v183
    v_and_b32 v182, s42, v182
    v_lshl_add_u32 v183, v99, 2, s10
    ds_write_b32 v183, v182
L_SC3:
    s_mov_b64 exec, -1
    s_waitcnt lgkmcnt(0)
    s_barrier
    ds_read_b128 v[196:199], v208 offset:0
    s_cmp_gt_i32 s35, 0
    s_cselect_b32 s37, 0, 0x80000000
    s_waitcnt lgkmcnt(0)
    v_or3_b32 v196, v196, v200, s37
    v_or3_b32 v197, v197, v201, s37
    v_or3_b32 v198, v198, v202, s37
    v_or3_b32 v199, v199, v203, s37
    s_add_u32 m0, s36, 0
    s_nop 0
    buffer_load_dwordx4 v196, s[12:15], 0 offen  lds
    s_add_u32 m0, s36, 1024
    s_nop 0
    buffer_load_dwordx4 v197, s[12:15], 0 offen  lds
    s_add_u32 m0, s36, 2048
    s_nop 0
    buffer_load_dwordx4 v198, s[12:15], 0 offen  lds
    s_add_u32 m0, s36, 3072
    s_nop 0
    buffer_load_dwordx4 v199, s[12:15], 0 offen  lds
    s_mov_b64 exec, s[44:45]
    v_lshl_add_u32 v76, v76, 3, s11
    ds_write_b64 v76, v[104:105]
    s_mov_b64 exec, s[46:47]
    v_lshl_add_u32 v77, v77, 3, s11
    ds_write_b64 v77, v[108:109]
    s_mov_b64 exec, s[48:49]
    v_lshl_add_u32 v78, v78, 3, s11
    ds_write_b64 v78, v[112:113]
    s_mov_b64 exec, s[50:51]
    v_lshl_add_u32 v79, v79, 3, s11
    ds_write_b64 v79, v[116:117]
    s_mov_b64 exec, s[52:53]
    v_lshl_add_u32 v80, v80, 3, s11
    ds_write_b64 v80, v[120:121]
    s_mov_b64 exec, s[54:55]
    v_lshl_add_u32 v81, v81, 3, s11
    ds_write_b64 v81, v[124:125]
    s_mov_b64 exec, s[56:57]
    v_lshl_add_u32 v82, v82, 3, s11
    ds_write_b64 v82, v[128:129]
    s_mov_b64 exec, s[58:59]
    v_lshl_add_u32 v83, v83, 3, s11
    ds_write_b64 v83, v[132:133]
    s_mov_b64 exec, s[60:61]
    v_lshl_add_u32 v84, v84, 3, s11
    ds_write_b64 v84, v[136:137]
    s_mov_b64 exec, s[62:63]
    v_lshl_add_u32 v85, v85, 3, s11
    ds_write_b64 v85, v[140:141]
    s_mov_b64 exec, s[64:65]
    v_lshl_add_u32 v86, v86, 3, s11
    ds_write_b64 v86, v[144:145]
    s_mov_b64 exec, s[66:67]
    v_lshl_add_u32 v87, v87, 3, s11
    ds_write_b64 v87, v[148:149]
    s_cmp_lt_u32 s40, 1
    s_cbranch_scc1 L_SE3
    s_mov_b64 exec, s[68:69]
    v_lshl_add_u32 v88, v88, 3, s11
    ds_write_b64 v88, v[152:153]
    s_mov_b64 exec, s[70:71]
    v_lshl_add_u32 v89, v89, 3, s11
    ds_write_b64 v89, v[156:157]
    s_mov_b64 exec, s[72:73]
    v_lshl_add_u32 v90, v90, 3, s11
    ds_write_b64 v90, v[160:161]
    s_mov_b64 exec, s[74:75]
    v_lshl_add_u32 v91, v91, 3, s11
    ds_write_b64 v91, v[164:165]
    s_cmp_lt_u32 s40, 2
    s_cbranch_scc1 L_SE3
    s_mov_b64 exec, s[76:77]
    v_lshl_add_u32 v96, v96, 3, s11
    ds_write_b64 v96, v[168:169]
    s_mov_b64 exec, s[78:79]
    v_lshl_add_u32 v97, v97, 3, s11
    ds_write_b64 v97, v[172:173]
    s_mov_b64 exec, s[80:81]
    v_lshl_add_u32 v98, v98, 3, s11
    ds_write_b64 v98, v[176:177]
    s_mov_b64 exec, s[82:83]
    v_lshl_add_u32 v99, v99, 3, s11
    ds_write_b64 v99, v[180:181]
L_SE3:
    s_mov_b64 exec, -1
    v_mul_u32_u24 v220, 1536, v213
    v_add_u32 v221, 768, v220
    s_lshl_b32 s3, s32, 2
L_GNL:
    v_cmp_lt_u32 vcc, s3, v218
    v_cmp_lt_u32 s[84:85], s3, v219
    v_add_u32 v214, s3, v222
    v_add_u32 v215, s3, v223
    s_mov_b64 exec, vcc
    ds_write_b32 v214, v220
    s_and_b64 exec, s[84:85], -1
    ds_write_b32 v215, v221
    s_mov_b64 exec, -1
    s_add_u32 s3, s3, 32
    s_or_b64 vcc, vcc, s[84:85]
    s_cbranch_scc1 L_GNL
    v_mov_b32 v168, 1.0
    v_mov_b32 v169, 1.0
    v_mov_b32 v170, 0
    v_mov_b32 v171, 0
    v_mov_b32 v172, 1.0
    v_mov_b32 v173, 1.0
    v_mov_b32 v174, 0
    v_mov_b32 v175, 0
    v_mov_b32 v188, v211
    v_mov_b32 v189, v211
    v_mov_b32 v190, v211
    v_mov_b32 v191, v211
    s_mov_b32 s10, 0x05040100
    s_mov_b32 s11, 0x07060302
    s_waitcnt lgkmcnt(0)
    s_barrier
    s_cmp_lt_i32 s35, 1
    s_cbranch_scc1 L_BEND
    ds_read_b128 v[192:195], v210 offset:0
    ds_read_b128 v[196:199], v208 offset:1024
    s_mov_b32 exec_hi, 0
    ds_read_b64 v[92:93], v209 offset:0
    s_mov_b64 exec, -1
    s_waitcnt lgkmcnt(2)
    v_add_u32 v184, v192, v211
    v_add_u32 v185, v193, v211
    v_add_u32 v186, v194, v211
    v_add_u32 v187, v195, v211
    ds_read_b32 v96, v184 offset:0
    ds_read_b32 v97, v185 offset:0
    ds_read_b32 v98, v186 offset:0
    ds_read_b32 v99, v187 offset:0
    ds_read_b128 v[192:195], v210 offset:256
    s_cmp_gt_i32 s35, 1
    s_cselect_b32 s37, 0, 0x80000000
    s_waitcnt vmcnt(0)
    ds_read_b128 v[76:79], v204
    ds_read_b128 v[80:83], v205
    ds_read_b128 v[84:87], v206
    ds_read_b128 v[88:91], v207
    s_waitcnt lgkmcnt(10)
    v_or3_b32 v196, v196, v200, s37
    v_or3_b32 v197, v197, v201, s37
    v_or3_b32 v198, v198, v202, s37
    v_or3_b32 v199, v199, v203, s37
    s_waitcnt lgkmcnt(7)
    v_perm_b32 v66, v97, v96, s10
    s_waitcnt lgkmcnt(5)
    v_perm_b32 v67, v99, v98, s10
    v_perm_b32 v70, v97, v96, s11
    v_perm_b32 v71, v99, v98, s11
    v_mfma_f32_32x32x16_bf16 v[104:119], v[92:95], v[64:67], 0
    s_waitcnt lgkmcnt(0)
    v_mfma_f32_32x32x16_bf16 v[104:119], v[76:79], v[0:3], v[104:119]
    s_add_u32 m0, s36, 0
    v_mfma_f32_32x32x16_bf16 v[120:135], v[76:79], v[32:35], 0
    buffer_load_dwordx4 v196, s[12:15], 0 offen  lds
    v_mfma_f32_32x32x16_bf16 v[104:119], v[80:83], v[8:11], v[104:119]
    s_add_u32 m0, s36, 1024
    v_mfma_f32_32x32x16_bf16 v[120:135], v[80:83], v[40:43], v[120:135]
    buffer_load_dwordx4 v197, s[12:15], 0 offen  lds
    v_mfma_f32_32x32x16_bf16 v[104:119], v[84:87], v[16:19], v[104:119]
    s_add_u32 m0, s36, 2048
    v_mfma_f32_32x32x16_bf16 v[120:135], v[84:87], v[48:51], v[120:135]
    buffer_load_dwordx4 v198, s[12:15], 0 offen  lds
    v_mfma_f32_32x32x16_bf16 v[104:119], v[88:91], v[24:27], v[104:119]
    s_add_u32 m0, s36, 3072
    v_mfma_f32_32x32x16_bf16 v[120:135], v[88:91], v[56:59], v[120:135]
    buffer_load_dwordx4 v199, s[12:15], 0 offen  lds
    ds_read_b128 v[196:199], v208 offset:2048
    s_waitcnt lgkmcnt(0)
    s_cmp_gt_i32 s35, 2
    s_cselect_b32 s37, 0, 0x80000000
    s_cmp_eq_u32 s35, 1
L_LOOP:
    v_mfma_f32_32x32x16_bf16 v[136:151], v[76:79], v[4:7], 0
    v_rcp_f32 v168, v168
    v_rcp_f32 v169, v169
    v_rcp_f32 v172, v172
    v_mfma_f32_32x32x16_bf16 v[152:167], v[76:79], v[36:39], 0
    v_rcp_f32 v173, v173
    v_mul_f32 v168, v170, v168
    v_mul_f32 v169, v171, v169
    v_mul_f32 v172, v174, v172
    v_mfma_f32_32x32x16_bf16 v[136:151], v[92:95], v[68:71], v[136:151]
    v_mul_f32 v173, v175, v173
    v_cvt_f64_f32 v[176:177], v168
    v_cvt_f64_f32 v[178:179], v169
    v_cvt_f64_f32 v[180:181], v172
    v_cvt_f64_f32 v[182:183], v173
    v_mfma_f32_32x32x16_bf16 v[136:151], v[80:83], v[12:15], v[136:151]
    v_or3_b32 v196, v196, v200, s37
    v_or3_b32 v197, v197, v201, s37
    v_or3_b32 v198, v198, v202, s37
    v_or3_b32 v199, v199, v203, s37
    v_exp_f32_e64 v104, v104 clamp
    v_mfma_f32_32x32x16_bf16 v[152:167], v[80:83], v[44:47], v[152:167]
    v_exp_f32_e64 v105, v105 clamp
    v_exp_f32_e64 v106, v106 clamp
    v_mfma_f32_32x32x16_bf16 v[136:151], v[84:87], v[20:23], v[136:151]
    v_exp_f32_e64 v107, v107 clamp
    v_exp_f32_e64 v108, v108 clamp
    v_exp_f32_e64 v109, v109 clamp
    v_mfma_f32_32x32x16_bf16 v[152:167], v[84:87], v[52:55], v[152:167]
    v_exp_f32_e64 v110, v110 clamp
    v_exp_f32_e64 v111, v111 clamp
    v_mfma_f32_32x32x16_bf16 v[136:151], v[88:91], v[28:31], v[136:151]
    v_exp_f32_e64 v112, v112 clamp
    v_exp_f32_e64 v113, v113 clamp
    v_exp_f32_e64 v114, v114 clamp
    v_mfma_f32_32x32x16_bf16 v[152:167], v[88:91], v[60:63], v[152:167]
    v_exp_f32_e64 v115, v115 clamp
    v_exp_f32_e64 v116, v116 clamp
    v_exp_f32_e64 v117, v117 clamp
    v_exp_f32_e64 v118, v118 clamp
    v_exp_f32_e64 v119, v119 clamp
    s_cbranch_scc1 L_TAIL0
    s_waitcnt vmcnt(0)
    ds_read_b128 v[76:79], v204
    ds_read_b128 v[80:83], v205
    ds_read_b128 v[84:87], v206
    ds_read_b128 v[88:91], v207
    s_mov_b32 exec_hi, 0
    ds_read_b64 v[92:93], v209 offset:2048
    s_mov_b64 exec, -1
    ds_add_f64 v188, v[176:177] offset:512
    ds_add_f64 v189, v[178:179] offset:512
    ds_add_f64 v190, v[180:181] offset:512
    ds_add_f64 v191, v[182:183] offset:512
    v_add_u32 v188, v192, v211
    v_add_u32 v189, v193, v211
    v_add_u32 v190, v194, v211
    v_add_u32 v191, v195, v211
    ds_read_b32 v96, v188 offset:0
    ds_read_b32 v97, v189 offset:0
    ds_read_b32 v98, v190 offset:0
    ds_read_b32 v99, v191 offset:0
    s_waitcnt lgkmcnt(9)
    s_add_u32 m0, s36, 0
    s_nop 0
    buffer_load_dwordx4 v196, s[12:15], 0 offen  lds
    s_add_u32 m0, s36, 1024
    s_nop 0
    buffer_load_dwordx4 v197, s[12:15], 0 offen  lds
    s_waitcnt lgkmcnt(0)
    v_pk_add_f32 v[106:107], v[106:107], s[38:39]
    v_pk_add_f32 v[114:115], v[114:115], s[38:39]
    v_pk_add_f32 v[110:111], v[110:111], s[38:39]
    v_pk_add_f32 v[118:119], v[118:119], s[38:39]
    v_pk_add_f32 v[104:105], v[104:105], s[38:39]
    v_pk_add_f32 v[112:113], v[112:113], s[38:39]
    v_pk_add_f32 v[108:109], v[108:109], s[38:39]
    v_pk_add_f32 v[116:117], v[116:117], s[38:39]
    v_pk_mul_f32 v[120:121], v[120:121], v[106:107]
    v_pk_mul_f32 v[128:129], v[128:129], v[114:115]
    v_pk_mul_f32 v[124:125], v[124:125], v[110:111]
    v_pk_mul_f32 v[132:133], v[132:133], v[118:119]
    v_pk_fma_f32 v[120:121], v[122:123], v[104:105], v[120:121]
    v_pk_fma_f32 v[128:129], v[130:131], v[112:113], v[128:129]
    v_pk_fma_f32 v[124:125], v[126:127], v[108:109], v[124:125]
    v_pk_fma_f32 v[132:133], v[134:135], v[116:117], v[132:133]
    v_pk_mul_f32 v[108:109], v[108:109], v[110:111]
    v_pk_mul_f32 v[116:117], v[116:117], v[118:119]
    v_pk_mul_f32 v[104:105], v[104:105], v[106:107]
    v_pk_mul_f32 v[112:113], v[112:113], v[114:115]
    v_pk_mul_f32 v[170:171], v[120:121], v[108:109]
    v_pk_mul_f32 v[174:175], v[128:129], v[116:117]
    v_pk_mul_f32 v[168:169], v[104:105], v[108:109]
    v_pk_mul_f32 v[172:173], v[112:113], v[116:117]
    v_pk_fma_f32 v[170:171], v[124:125], v[104:105], v[170:171]
    v_pk_fma_f32 v[174:175], v[132:133], v[112:113], v[174:175]
    v_mfma_f32_32x32x16_bf16 v[104:119], v[76:79], v[0:3], 0
    v_perm_b32 v66, v97, v96, s10
    v_perm_b32 v67, v99, v98, s10
    v_perm_b32 v70, v97, v96, s11
    v_perm_b32 v71, v99, v98, s11
    v_rcp_f32 v168, v168
    v_mfma_f32_32x32x16_bf16 v[120:135], v[76:79], v[32:35], 0
    v_rcp_f32 v169, v169
    v_rcp_f32 v172, v172
    v_mfma_f32_32x32x16_bf16 v[104:119], v[92:95], v[64:67], v[104:119]
    v_rcp_f32 v173, v173
    v_mul_f32 v168, v170, v168
    v_mul_f32 v169, v171, v169
    v_mul_f32 v172, v174, v172
    v_mul_f32 v173, v175, v173
    v_mfma_f32_32x32x16_bf16 v[104:119], v[80:83], v[8:11], v[104:119]
    v_cvt_f64_f32 v[176:177], v168
    v_cvt_f64_f32 v[178:179], v169
    v_cvt_f64_f32 v[180:181], v172
    v_cvt_f64_f32 v[182:183], v173
    v_exp_f32_e64 v136, v136 clamp
    v_mfma_f32_32x32x16_bf16 v[120:135], v[80:83], v[40:43], v[120:135]
    v_exp_f32_e64 v137, v137 clamp
    v_exp_f32_e64 v138, v138 clamp
    v_mfma_f32_32x32x16_bf16 v[104:119], v[84:87], v[16:19], v[104:119]
    v_exp_f32_e64 v139, v139 clamp
    v_exp_f32_e64 v140, v140 clamp
    v_exp_f32_e64 v141, v141 clamp
    v_mfma_f32_32x32x16_bf16 v[120:135], v[84:87], v[48:51], v[120:135]
    v_exp_f32_e64 v142, v142 clamp
    v_exp_f32_e64 v143, v143 clamp
    v_mfma_f32_32x32x16_bf16 v[104:119], v[88:91], v[24:27], v[104:119]
    v_exp_f32_e64 v144, v144 clamp
    v_exp_f32_e64 v145, v145 clamp
    v_exp_f32_e64 v146, v146 clamp
    v_mfma_f32_32x32x16_bf16 v[120:135], v[88:91], v[56:59], v[120:135]
    v_exp_f32_e64 v147, v147 clamp
    v_exp_f32_e64 v148, v148 clamp
    v_exp_f32_e64 v149, v149 clamp
    v_exp_f32_e64 v150, v150 clamp
    v_exp_f32_e64 v151, v151 clamp
    s_add_u32 m0, s36, 2048
    s_nop 0
    buffer_load_dwordx4 v198, s[12:15], 0 offen  lds
    s_add_u32 m0, s36, 3072
    s_nop 0
    buffer_load_dwordx4 v199, s[12:15], 0 offen  lds
    ds_read_b128 v[192:195], v210 offset:512
    ds_read_b128 v[196:199], v208 offset:3072
    ds_add_f64 v184, v[176:177] offset:256
    ds_add_f64 v185, v[178:179] offset:256
    ds_add_f64 v186, v[180:181] offset:256
    ds_add_f64 v187, v[182:183] offset:256
    s_sub_u32 s35, s35, 1
    s_cmp_gt_i32 s35, 2
    s_cselect_b32 s37, 0, 0x80000000
    s_cmp_eq_u32 s35, 1
    s_waitcnt lgkmcnt(0)
    v_pk_add_f32 v[138:139], v[138:139], s[38:39]
    v_pk_add_f32 v[146:147], v[146:147], s[38:39]
    v_pk_add_f32 v[142:143], v[142:143], s[38:39]
    v_pk_add_f32 v[150:151], v[150:151], s[38:39]
    v_pk_add_f32 v[136:137], v[136:137], s[38:39]
    v_pk_add_f32 v[144:145], v[144:145], s[38:39]
    v_pk_add_f32 v[140:141], v[140:141], s[38:39]
    v_pk_add_f32 v[148:149], v[148:149], s[38:39]
    v_pk_mul_f32 v[152:153], v[152:153], v[138:139]
    v_pk_mul_f32 v[160:161], v[160:161], v[146:147]
    v_pk_mul_f32 v[156:157], v[156:157], v[142:143]
    v_pk_mul_f32 v[164:165], v[164:165], v[150:151]
    v_pk_fma_f32 v[152:153], v[154:155], v[136:137], v[152:153]
    v_pk_fma_f32 v[160:161], v[162:163], v[144:145], v[160:161]
    v_pk_fma_f32 v[156:157], v[158:159], v[140:141], v[156:157]
    v_pk_fma_f32 v[164:165], v[166:167], v[148:149], v[164:165]
    v_pk_mul_f32 v[140:141], v[140:141], v[142:143]
    v_pk_mul_f32 v[148:149], v[148:149], v[150:151]
    v_pk_mul_f32 v[136:137], v[136:137], v[138:139]
    v_pk_mul_f32 v[144:145], v[144:145], v[146:147]
    v_pk_mul_f32 v[170:171], v[152:153], v[140:141]
    v_pk_mul_f32 v[174:175], v[160:161], v[148:149]
    v_pk_mul_f32 v[168:169], v[136:137], v[140:141]
    v_pk_mul_f32 v[172:173], v[144:145], v[148:149]
    v_pk_fma_f32 v[170:171], v[156:157], v[136:137], v[170:171]
    v_pk_fma_f32 v[174:175], v[164:165], v[144:145], v[174:175]
    v_mfma_f32_32x32x16_bf16 v[136:151], v[76:79], v[4:7], 0
    v_rcp_f32 v168, v168
    v_rcp_f32 v169, v169
    v_rcp_f32 v172, v172
    v_mfma_f32_32x32x16_bf16 v[152:167], v[76:79], v[36:39], 0
    v_rcp_f32 v173, v173
    v_mul_f32 v168, v170, v168
    v_mul_f32 v169, v171, v169
    v_mul_f32 v172, v174, v172
    v_mfma_f32_32x32x16_bf16 v[136:151], v[92:95], v[68:71], v[136:151]
    v_mul_f32 v173, v175, v173
    v_cvt_f64_f32 v[176:177], v168
    v_cvt_f64_f32 v[178:179], v169
    v_cvt_f64_f32 v[180:181], v172
    v_cvt_f64_f32 v[182:183], v173
    v_mfma_f32_32x32x16_bf16 v[136:151], v[80:83], v[12:15], v[136:151]
    v_or3_b32 v196, v196, v200, s37
    v_or3_b32 v197, v197, v201, s37
    v_or3_b32 v198, v198, v202, s37
    v_or3_b32 v199, v199, v203, s37
    v_exp_f32_e64 v104, v104 clamp
    v_mfma_f32_32x32x16_bf16 v[152:167], v[80:83], v[44:47], v[152:167]
    v_exp_f32_e64 v105, v105 clamp
    v_exp_f32_e64 v106, v106 clamp
    v_mfma_f32_32x32x16_bf16 v[136:151], v[84:87], v[20:23], v[136:151]
    v_exp_f32_e64 v107, v107 clamp
    v_exp_f32_e64 v108, v108 clamp
    v_exp_f32_e64 v109, v109 clamp
    v_mfma_f32_32x32x16_bf16 v[152:167], v[84:87], v[52:55], v[152:167]
    v_exp_f32_e64 v110, v110 clamp
    v_exp_f32_e64 v111, v111 clamp
    v_mfma_f32_32x32x16_bf16 v[136:151], v[88:91], v[28:31], v[136:151]
    v_exp_f32_e64 v112, v112 clamp
    v_exp_f32_e64 v113, v113 clamp
    v_exp_f32_e64 v114, v114 clamp
    v_mfma_f32_32x32x16_bf16 v[152:167], v[88:91], v[60:63], v[152:167]
    v_exp_f32_e64 v115, v115 clamp
    v_exp_f32_e64 v116, v116 clamp
    v_exp_f32_e64 v117, v117 clamp
    v_exp_f32_e64 v118, v118 clamp
    v_exp_f32_e64 v119, v119 clamp
    s_cbranch_scc1 L_TAIL1
    s_waitcnt vmcnt(0)
    ds_read_b128 v[76:79], v204
    ds_read_b128 v[80:83], v205
    ds_read_b128 v[84:87], v206
    ds_read_b128 v[88:91], v207
    s_mov_b32 exec_hi, 0
    ds_read_b64 v[92:93], v209 offset:4096
    s_mov_b64 exec, -1
    ds_add_f64 v184, v[176:177] offset:512
    ds_add_f64 v185, v[178:179] offset:512
    ds_add_f64 v186, v[180:181] offset:512
    ds_add_f64 v187, v[182:183] offset:512
    v_add_u32 v184, v192, v211
    v_add_u32 v185, v193, v211
    v_add_u32 v186, v194, v211
    v_add_u32 v187, v195, v211
    ds_read_b32 v96, v184 offset:0
    ds_read_b32 v97, v185 offset:0
    ds_read_b32 v98, v186 offset:0
    ds_read_b32 v99, v187 offset:0
    s_waitcnt lgkmcnt(9)
    s_add_u32 m0, s36, 0
    s_nop 0
    buffer_load_dwordx4 v196, s[12:15], 0 offen  lds
    s_add_u32 m0, s36, 1024
    s_nop 0
    buffer_load_dwordx4 v197, s[12:15], 0 offen  lds
    s_waitcnt lgkmcnt(0)
    v_pk_add_f32 v[106:107], v[106:107], s[38:39]
    v_pk_add_f32 v[114:115], v[114:115], s[38:39]
    v_pk_add_f32 v[110:111], v[110:111], s[38:39]
    v_pk_add_f32 v[118:119], v[118:119], s[38:39]
    v_pk_add_f32 v[104:105], v[104:105], s[38:39]
    v_pk_add_f32 v[112:113], v[112:113], s[38:39]
    v_pk_add_f32 v[108:109], v[108:109], s[38:39]
    v_pk_add_f32 v[116:117], v[116:117], s[38:39]
    v_pk_mul_f32 v[120:121], v[120:121], v[106:107]
    v_pk_mul_f32 v[128:129], v[128:129], v[114:115]
    v_pk_mul_f32 v[124:125], v[124:125], v[110:111]
    v_pk_mul_f32 v[132:133], v[132:133], v[118:119]
    v_pk_fma_f32 v[120:121], v[122:123], v[104:105], v[120:121]
    v_pk_fma_f32 v[128:129], v[130:131], v[112:113], v[128:129]
    v_pk_fma_f32 v[124:125], v[126:127], v[108:109], v[124:125]
    v_pk_fma_f32 v[132:133], v[134:135], v[116:117], v[132:133]
    v_pk_mul_f32 v[108:109], v[108:109], v[110:111]
    v_pk_mul_f32 v[116:117], v[116:117], v[118:119]
    v_pk_mul_f32 v[104:105], v[104:105], v[106:107]
    v_pk_mul_f32 v[112:113], v[112:113], v[114:115]
    v_pk_mul_f32 v[170:171], v[120:121], v[108:109]
    v_pk_mul_f32 v[174:175], v[128:129], v[116:117]
    v_pk_mul_f32 v[168:169], v[104:105], v[108:109]
    v_pk_mul_f32 v[172:173], v[112:113], v[116:117]
    v_pk_fma_f32 v[170:171], v[124:125], v[104:105], v[170:171]
    v_pk_fma_f32 v[174:175], v[132:133], v[112:113], v[174:175]
    v_mfma_f32_32x32x16_bf16 v[104:119], v[76:79], v[0:3], 0
    v_perm_b32 v66, v97, v96, s10
    v_perm_b32 v67, v99, v98, s10
    v_perm_b32 v70, v97, v96, s11
    v_perm_b32 v71, v99, v98, s11
    v_rcp_f32 v168, v168
    v_mfma_f32_32x32x16_bf16 v[120:135], v[76:79], v[32:35], 0
    v_rcp_f32 v169, v169
    v_rcp_f32 v172, v172
    v_mfma_f32_32x32x16_bf16 v[104:119], v[92:95], v[64:67], v[104:119]
    v_rcp_f32 v173, v173
    v_mul_f32 v168, v170, v168
    v_mul_f32 v169, v171, v169
    v_mul_f32 v172, v174, v172
    v_mul_f32 v173, v175, v173
    v_mfma_f32_32x32x16_bf16 v[104:119], v[80:83], v[8:11], v[104:119]
    v_cvt_f64_f32 v[176:177], v168
    v_cvt_f64_f32 v[178:179], v169
    v_cvt_f64_f32 v[180:181], v172
    v_cvt_f64_f32 v[182:183], v173
    v_exp_f32_e64 v136, v136 clamp
    v_mfma_f32_32x32x16_bf16 v[120:135], v[80:83], v[40:43], v[120:135]
    v_exp_f32_e64 v137, v137 clamp
    v_exp_f32_e64 v138, v138 clamp
    v_mfma_f32_32x32x16_bf16 v[104:119], v[84:87], v[16:19], v[104:119]
    v_exp_f32_e64 v139, v139 clamp
    v_exp_f32_e64 v140, v140 clamp
    v_exp_f32_e64 v141, v141 clamp
    v_mfma_f32_32x32x16_bf16 v[120:135], v[84:87], v[48:51], v[120:135]
    v_exp_f32_e64 v142, v142 clamp
    v_exp_f32_e64 v143, v143 clamp
    v_mfma_f32_32x32x16_bf16 v[104:119], v[88:91], v[24:27], v[104:119]
    v_exp_f32_e64 v144, v144 clamp
    v_exp_f32_e64 v145, v145 clamp
    v_exp_f32_e64 v146, v146 clamp
    v_mfma_f32_32x32x16_bf16 v[120:135], v[88:91], v[56:59], v[120:135]
    v_exp_f32_e64 v147, v147 clamp
    v_exp_f32_e64 v148, v148 clamp
    v_exp_f32_e64 v149, v149 clamp
    v_exp_f32_e64 v150, v150 clamp
    v_exp_f32_e64 v151, v151 clamp
    s_add_u32 m0, s36, 2048
    s_nop 0
    buffer_load_dwordx4 v198, s[12:15], 0 offen  lds
    s_add_u32 m0, s36, 3072
    s_nop 0
    buffer_load_dwordx4 v199, s[12:15], 0 offen  lds
    ds_read_b128 v[192:195], v210 offset:768
    ds_read_b128 v[196:199], v208 offset:4096
    ds_add_f64 v188, v[176:177] offset:256
    ds_add_f64 v189, v[178:179] offset:256
    ds_add_f64 v190, v[180:181] offset:256
    ds_add_f64 v191, v[182:183] offset:256
    v_add_u32 v208, 2048, v208
    v_add_u32 v209, 4096, v209
    v_add_u32 v210, 512, v210
    s_sub_u32 s35, s35, 1
    s_cmp_gt_i32 s35, 2
    s_cselect_b32 s37, 0, 0x80000000
    s_cmp_eq_u32 s35, 1
    s_waitcnt lgkmcnt(0)
    v_pk_add_f32 v[138:139], v[138:139], s[38:39]
    v_pk_add_f32 v[146:147], v[146:147], s[38:39]
    v_pk_add_f32 v[142:143], v[142:143], s[38:39]
    v_pk_add_f32 v[150:151], v[150:151], s[38:39]
    v_pk_add_f32 v[136:137], v[136:137], s[38:39]
    v_pk_add_f32 v[144:145], v[144:145], s[38:39]
    v_pk_add_f32 v[140:141], v[140:141], s[38:39]
    v_pk_add_f32 v[148:149], v[148:149], s[38:39]
    v_pk_mul_f32 v[152:153], v[152:153], v[138:139]
    v_pk_mul_f32 v[160:161], v[160:161], v[146:147]
    v_pk_mul_f32 v[156:157], v[156:157], v[142:143]
    v_pk_mul_f32 v[164:165], v[164:165], v[150:151]
    v_pk_fma_f32 v[152:153], v[154:155], v[136:137], v[152:153]
    v_pk_fma_f32 v[160:161], v[162:163], v[144:145], v[160:161]
    v_pk_fma_f32 v[156:157], v[158:159], v[140:141], v[156:157]
    v_pk_fma_f32 v[164:165], v[166:167], v[148:149], v[164:165]
    v_pk_mul_f32 v[140:141], v[140:141], v[142:143]
    v_pk_mul_f32 v[148:149], v[148:149], v[150:151]
    v_pk_mul_f32 v[136:137], v[136:137], v[138:139]
    v_pk_mul_f32 v[144:145], v[144:145], v[146:147]
    v_pk_mul_f32 v[170:171], v[152:153], v[140:141]
    v_pk_mul_f32 v[174:175], v[160:161], v[148:149]
    v_pk_mul_f32 v[168:169], v[136:137], v[140:141]
    v_pk_mul_f32 v[172:173], v[144:145], v[148:149]
    v_pk_fma_f32 v[170:171], v[156:157], v[136:137], v[170:171]
    v_pk_fma_f32 v[174:175], v[164:165], v[144:145], v[174:175]
    s_branch L_LOOP
L_TAIL0:
    s_nop 0
    ds_add_f64 v188, v[176:177] offset:512
    ds_add_f64 v189, v[178:179] offset:512
    ds_add_f64 v190, v[180:181] offset:512
    ds_add_f64 v191, v[182:183] offset:512
    v_pk_add_f32 v[106:107], v[106:107], s[38:39]
    v_pk_add_f32 v[114:115], v[114:115], s[38:39]
    v_pk_add_f32 v[110:111], v[110:111], s[38:39]
    v_pk_add_f32 v[118:119], v[118:119], s[38:39]
    v_pk_add_f32 v[104:105], v[104:105], s[38:39]
    v_pk_add_f32 v[112:113], v[112:113], s[38:39]
    v_pk_add_f32 v[108:109], v[108:109], s[38:39]
    v_pk_add_f32 v[116:117], v[116:117], s[38:39]
    v_pk_mul_f32 v[120:121], v[120:121], v[106:107]
    v_pk_mul_f32 v[128:129], v[128:129], v[114:115]
    v_pk_mul_f32 v[124:125], v[124:125], v[110:111]
    v_pk_mul_f32 v[132:133], v[132:133], v[118:119]
    v_pk_fma_f32 v[120:121], v[122:123], v[104:105], v[120:121]
    v_pk_fma_f32 v[128:129], v[130:131], v[112:113], v[128:129]
    v_pk_fma_f32 v[124:125], v[126:127], v[108:109], v[124:125]
    v_pk_fma_f32 v[132:133], v[134:135], v[116:117], v[132:133]
    v_pk_mul_f32 v[108:109], v[108:109], v[110:111]
    v_pk_mul_f32 v[116:117], v[116:117], v[118:119]
    v_pk_mul_f32 v[104:105], v[104:105], v[106:107]
    v_pk_mul_f32 v[112:113], v[112:113], v[114:115]
    v_pk_mul_f32 v[170:171], v[120:121], v[108:109]
    v_pk_mul_f32 v[174:175], v[128:129], v[116:117]
    v_pk_mul_f32 v[168:169], v[104:105], v[108:109]
    v_pk_mul_f32 v[172:173], v[112:113], v[116:117]
    v_pk_fma_f32 v[170:171], v[124:125], v[104:105], v[170:171]
    v_pk_fma_f32 v[174:175], v[132:133], v[112:113], v[174:175]
    v_rcp_f32 v168, v168
    v_rcp_f32 v169, v169
    v_rcp_f32 v172, v172
    v_rcp_f32 v173, v173
    v_exp_f32_e64 v136, v136 clamp
    v_exp_f32_e64 v137, v137 clamp
    v_exp_f32_e64 v138, v138 clamp
    v_exp_f32_e64 v139, v139 clamp
    v_exp_f32_e64 v140, v140 clamp
    v_exp_f32_e64 v141, v141 clamp
    v_exp_f32_e64 v142, v142 clamp
    v_exp_f32_e64 v143, v143 clamp
    v_exp_f32_e64 v144, v144 clamp
    v_exp_f32_e64 v145, v145 clamp
    v_exp_f32_e64 v146, v146 clamp
    v_exp_f32_e64 v147, v147 clamp
    v_exp_f32_e64 v148, v148 clamp
    v_exp_f32_e64 v149, v149 clamp
    v_exp_f32_e64 v150, v150 clamp
    v_exp_f32_e64 v151, v151 clamp
    v_mul_f32 v168, v170, v168
    v_mul_f32 v169, v171, v169
    v_mul_f32 v172, v174, v172
    v_mul_f32 v173, v175, v173
    v_cvt_f64_f32 v[176:177], v168
    v_cvt_f64_f32 v[178:179], v169
    v_cvt_f64_f32 v[180:181], v172
    v_cvt_f64_f32 v[182:183], v173
    ds_add_f64 v184, v[176:177] offset:256
    ds_add_f64 v185, v[178:179] offset:256
    ds_add_f64 v186, v[180:181] offset:256
    ds_add_f64 v187, v[182:183] offset:256
    v_pk_add_f32 v[138:139], v[138:139], s[38:39]
    v_pk_add_f32 v[146:147], v[146:147], s[38:39]
    v_pk_add_f32 v[142:143], v[142:143], s[38:39]
    v_pk_add_f32 v[150:151], v[150:151], s[38:39]
    v_pk_add_f32 v[136:137], v[136:137], s[38:39]
    v_pk_add_f32 v[144:145], v[144:145], s[38:39]
    v_pk_add_f32 v[140:141], v[140:141], s[38:39]
    v_pk_add_f32 v[148:149], v[148:149], s[38:39]
    v_pk_mul_f32 v[152:153], v[152:153], v[138:139]
    v_pk_mul_f32 v[160:161], v[160:161], v[146:147]
    v_pk_mul_f32 v[156:157], v[156:157], v[142:143]
    v_pk_mul_f32 v[164:165], v[164:165], v[150:151]
    v_pk_fma_f32 v[152:153], v[154:155], v[136:137], v[152:153]
    v_pk_fma_f32 v[160:161], v[162:163], v[144:145], v[160:161]
    v_pk_fma_f32 v[156:157], v[158:159], v[140:141], v[156:157]
    v_pk_fma_f32 v[164:165], v[166:167], v[148:149], v[164:165]
    v_pk_mul_f32 v[140:141], v[140:141], v[142:143]
    v_pk_mul_f32 v[148:149], v[148:149], v[150:151]
    v_pk_mul_f32 v[136:137], v[136:137], v[138:139]
    v_pk_mul_f32 v[144:145], v[144:145], v[146:147]
    v_pk_mul_f32 v[170:171], v[152:153], v[140:141]
    v_pk_mul_f32 v[174:175], v[160:161], v[148:149]
    v_pk_mul_f32 v[168:169], v[136:137], v[140:141]
    v_pk_mul_f32 v[172:173], v[144:145], v[148:149]
    v_pk_fma_f32 v[170:171], v[156:157], v[136:137], v[170:171]
    v_pk_fma_f32 v[174:175], v[164:165], v[144:145], v[174:175]
    v_rcp_f32 v168, v168
    v_rcp_f32 v169, v169
    v_rcp_f32 v172, v172
    v_rcp_f32 v173, v173
    v_mul_f32 v168, v170, v168
    v_mul_f32 v169, v171, v169
    v_mul_f32 v172, v174, v172
    v_mul_f32 v173, v175, v173
    v_cvt_f64_f32 v[176:177], v168
    v_cvt_f64_f32 v[178:179], v169
    v_cvt_f64_f32 v[180:181], v172
    v_cvt_f64_f32 v[182:183], v173
    ds_add_f64 v184, v[176:177] offset:512
    ds_add_f64 v185, v[178:179] offset:512
    ds_add_f64 v186, v[180:181] offset:512
    ds_add_f64 v187, v[182:183] offset:512
    s_branch L_BEND
L_TAIL1:
    s_nop 0
    ds_add_f64 v184, v[176:177] offset:512
    ds_add_f64 v185, v[178:179] offset:512
    ds_add_f64 v186, v[180:181] offset:512
    ds_add_f64 v187, v[182:183] offset:512
    v_pk_add_f32 v[106:107], v[106:107], s[38:39]
    v_pk_add_f32 v[114:115], v[114:115], s[38:39]
    v_pk_add_f32 v[110:111], v[110:111], s[38:39]
    v_pk_add_f32 v[118:119], v[118:119], s[38:39]
    v_pk_add_f32 v[104:105], v[104:105], s[38:39]
    v_pk_add_f32 v[112:113], v[112:113], s[38:39]
    v_pk_add_f32 v[108:109], v[108:109], s[38:39]
    v_pk_add_f32 v[116:117], v[116:117], s[38:39]
    v_pk_mul_f32 v[120:121], v[120:121], v[106:107]
    v_pk_mul_f32 v[128:129], v[128:129], v[114:115]
    v_pk_mul_f32 v[124:125], v[124:125], v[110:111]
    v_pk_mul_f32 v[132:133], v[132:133], v[118:119]
    v_pk_fma_f32 v[120:121], v[122:123], v[104:105], v[120:121]
    v_pk_fma_f32 v[128:129], v[130:131], v[112:113], v[128:129]
    v_pk_fma_f32 v[124:125], v[126:127], v[108:109], v[124:125]
    v_pk_fma_f32 v[132:133], v[134:135], v[116:117], v[132:133]
    v_pk_mul_f32 v[108:109], v[108:109], v[110:111]
    v_pk_mul_f32 v[116:117], v[116:117], v[118:119]
    v_pk_mul_f32 v[104:105], v[104:105], v[106:107]
    v_pk_mul_f32 v[112:113], v[112:113], v[114:115]
    v_pk_mul_f32 v[170:171], v[120:121], v[108:109]
    v_pk_mul_f32 v[174:175], v[128:129], v[116:117]
    v_pk_mul_f32 v[168:169], v[104:105], v[108:109]
    v_pk_mul_f32 v[172:173], v[112:113], v[116:117]
    v_pk_fma_f32 v[170:171], v[124:125], v[104:105], v[170:171]
    v_pk_fma_f32 v[174:175], v[132:133], v[112:113], v[174:175]
    v_rcp_f32 v168, v168
    v_rcp_f32 v169, v169
    v_rcp_f32 v172, v172
    v_rcp_f32 v173, v173
    v_exp_f32_e64 v136, v136 clamp
    v_exp_f32_e64 v137, v137 clamp
    v_exp_f32_e64 v138, v138 clamp
    v_exp_f32_e64 v139, v139 clamp
    v_exp_f32_e64 v140, v140 clamp
    v_exp_f32_e64 v141, v141 clamp
    v_exp_f32_e64 v142, v142 clamp
    v_exp_f32_e64 v143, v143 clamp
    v_exp_f32_e64 v144, v144 clamp
    v_exp_f32_e64 v145, v145 clamp
    v_exp_f32_e64 v146, v146 clamp
    v_exp_f32_e64 v147, v147 clamp
    v_exp_f32_e64 v148, v148 clamp
    v_exp_f32_e64 v149, v149 clamp
    v_exp_f32_e64 v150, v150 clamp
    v_exp_f32_e64 v151, v151 clamp
    v_mul_f32 v168, v170, v168
    v_mul_f32 v169, v171, v169
    v_mul_f32 v172, v174, v172
    v_mul_f32 v173, v175, v173
    v_cvt_f64_f32 v[176:177], v168
    v_cvt_f64_f32 v[178:179], v169
    v_cvt_f64_f32 v[180:181], v172
    v_cvt_f64_f32 v[182:183], v173
    ds_add_f64 v188, v[176:177] offset:256
    ds_add_f64 v189, v[178:179] offset:256
    ds_add_f64 v190, v[180:181] offset:256
    ds_add_f64 v191, v[182:183] offset:256
    v_pk_add_f32 v[138:139], v[138:139], s[38:39]
    v_pk_add_f32 v[146:147], v[146:147], s[38:39]
    v_pk_add_f32 v[142:143], v[142:143], s[38:39]
    v_pk_add_f32 v[150:151], v[150:151], s[38:39]
    v_pk_add_f32 v[136:137], v[136:137], s[38:39]
    v_pk_add_f32 v[144:145], v[144:145], s[38:39]
    v_pk_add_f32 v[140:141], v[140:141], s[38:39]
    v_pk_add_f32 v[148:149], v[148:149], s[38:39]
    v_pk_mul_f32 v[152:153], v[152:153], v[138:139]
    v_pk_mul_f32 v[160:161], v[160:161], v[146:147]
    v_pk_mul_f32 v[156:157], v[156:157], v[142:143]
    v_pk_mul_f32 v[164:165], v[164:165], v[150:151]
    v_pk_fma_f32 v[152:153], v[154:155], v[136:137], v[152:153]
    v_pk_fma_f32 v[160:161], v[162:163], v[144:145], v[160:161]
    v_pk_fma_f32 v[156:157], v[158:159], v[140:141], v[156:157]
    v_pk_fma_f32 v[164:165], v[166:167], v[148:149], v[164:165]
    v_pk_mul_f32 v[140:141], v[140:141], v[142:143]
    v_pk_mul_f32 v[148:149], v[148:149], v[150:151]
    v_pk_mul_f32 v[136:137], v[136:137], v[138:139]
    v_pk_mul_f32 v[144:145], v[144:145], v[146:147]
    v_pk_mul_f32 v[170:171], v[152:153], v[140:141]
    v_pk_mul_f32 v[174:175], v[160:161], v[148:149]
    v_pk_mul_f32 v[168:169], v[136:137], v[140:141]
    v_pk_mul_f32 v[172:173], v[144:145], v[148:149]
    v_pk_fma_f32 v[170:171], v[156:157], v[136:137], v[170:171]
    v_pk_fma_f32 v[174:175], v[164:165], v[144:145], v[174:175]
    v_rcp_f32 v168, v168
    v_rcp_f32 v169, v169
    v_rcp_f32 v172, v172
    v_rcp_f32 v173, v173
    v_mul_f32 v168, v170, v168
    v_mul_f32 v169, v171, v169
    v_mul_f32 v172, v174, v172
    v_mul_f32 v173, v175, v173
    v_cvt_f64_f32 v[176:177], v168
    v_cvt_f64_f32 v[178:179], v169
    v_cvt_f64_f32 v[180:181], v172
    v_cvt_f64_f32 v[182:183], v173
    ds_add_f64 v188, v[176:177] offset:512
    ds_add_f64 v189, v[178:179] offset:512
    ds_add_f64 v190, v[180:181] offset:512
    ds_add_f64 v191, v[182:183] offset:512
L_BEND:
    s_setprio 0
    v_lshrrev_b32 v214, 3, v212
    v_mul_u32_u24 v214, 768, v214
    v_and_b32 v215, 7, v212
    v_lshl_add_u32 v214, v215, 6, v214
    v_lshlrev_b32 v215, 4, v212
    s_mul_i32 s10, s2, 12544
    s_mov_b32 s42, 0x4e800000
    s_mov_b32 s43, 0xb0b8aa3b
    s_waitcnt vmcnt(0) lgkmcnt(0)
    s_nop 7
    s_barrier
    s_cmp_lg_u32 s86, 0
    s_cbranch_scc1 L_NEXT
    ds_read_b128 v[120:123], v214 offset:256
    ds_read_b128 v[124:127], v214 offset:272
    ds_read_b128 v[128:131], v214 offset:288
    ds_read_b128 v[132:135], v214 offset:304
    s_cmp_ge_u32 s32, 5
    s_cbranch_scc1 L_EP1
    ds_read_b128 v[160:163], v214 offset:49408
    ds_read_b128 v[164:167], v214 offset:49424
    ds_read_b128 v[168:171], v214 offset:49440
    ds_read_b128 v[172:175], v214 offset:49456
L_EP1:
    s_waitcnt lgkmcnt(3)
    v_cvt_f32_f64 v104, v[120:121]
    v_cvt_f32_f64 v105, v[122:123]
    s_waitcnt lgkmcnt(2)
    v_cvt_f32_f64 v106, v[124:125]
    v_cvt_f32_f64 v107, v[126:127]
    s_waitcnt lgkmcnt(1)
    v_cvt_f32_f64 v108, v[128:129]
    v_cvt_f32_f64 v109, v[130:131]
    s_waitcnt lgkmcnt(0)
    v_cvt_f32_f64 v110, v[132:133]
    v_cvt_f32_f64 v111, v[134:135]
    v_pk_mul_f32 v[112:113], v[104:105], s[42:43] op_sel:[0,1] op_sel_hi:[1,1]
    v_pk_mul_f32 v[114:115], v[106:107], s[42:43] op_sel:[0,1] op_sel_hi:[1,1]
    v_pk_mul_f32 v[116:117], v[108:109], s[42:43] op_sel:[0,1] op_sel_hi:[1,1]
    v_pk_mul_f32 v[118:119], v[110:111], s[42:43] op_sel:[0,1] op_sel_hi:[1,1]
    v_exp_f32 v112, v112
    v_exp_f32 v113, v113
    v_exp_f32 v114, v114
    v_exp_f32 v115, v115
    v_exp_f32 v116, v116
    v_exp_f32 v117, v117
    v_exp_f32 v118, v118
    v_exp_f32 v119, v119
    v_pk_fma_f32 v[112:113], v[112:113], s[42:43], s[42:43] op_sel_hi:[1,0,0]
    v_pk_fma_f32 v[114:115], v[114:115], s[42:43], s[42:43] op_sel_hi:[1,0,0]
    v_pk_fma_f32 v[116:117], v[116:117], s[42:43], s[42:43] op_sel_hi:[1,0,0]
    v_pk_fma_f32 v[118:119], v[118:119], s[42:43], s[42:43] op_sel_hi:[1,0,0]
    v_rcp_f32 v112, v112
    v_rcp_f32 v113, v113
    v_rcp_f32 v114, v114
    v_rcp_f32 v115, v115
    v_rcp_f32 v116, v116
    v_rcp_f32 v117, v117
    v_rcp_f32 v118, v118
    v_rcp_f32 v119, v119
    v_pk_mul_f32 v[104:105], v[104:105], v[112:113]
    v_pk_mul_f32 v[106:107], v[106:107], v[114:115]
    v_pk_mul_f32 v[108:109], v[108:109], v[116:117]
    v_pk_mul_f32 v[110:111], v[110:111], v[118:119]
    v_cvt_pk_bf16_f32 v136, v104, v105
    v_cvt_pk_bf16_f32 v137, v106, v107
    v_cvt_pk_bf16_f32 v138, v108, v109
    v_cvt_pk_bf16_f32 v139, v110, v111
    buffer_store_dwordx4 v[136:139], v215, s[28:31], s10 offen
    s_movk_i32 s11, 272
    v_cmp_gt_u32 vcc, s11, v212
    s_nop 0
    s_and_saveexec_b64 s[84:85], vcc
    s_cbranch_execz L_FIN
    s_add_u32 s10, s10, 8192
    v_cvt_f32_f64 v144, v[160:161]
    v_cvt_f32_f64 v145, v[162:163]
    v_cvt_f32_f64 v146, v[164:165]
    v_cvt_f32_f64 v147, v[166:167]
    v_cvt_f32_f64 v148, v[168:169]
    v_cvt_f32_f64 v149, v[170:171]
    v_cvt_f32_f64 v150, v[172:173]
    v_cvt_f32_f64 v151, v[174:175]
    v_pk_mul_f32 v[152:153], v[144:145], s[42:43] op_sel:[0,1] op_sel_hi:[1,1]
    v_pk_mul_f32 v[154:155], v[146:147], s[42:43] op_sel:[0,1] op_sel_hi:[1,1]
    v_pk_mul_f32 v[156:157], v[148:149], s[42:43] op_sel:[0,1] op_sel_hi:[1,1]
    v_pk_mul_f32 v[158:159], v[150:151], s[42:43] op_sel:[0,1] op_sel_hi:[1,1]
    v_exp_f32 v152, v152
    v_exp_f32 v153, v153
    v_exp_f32 v154, v154
    v_exp_f32 v155, v155
    v_exp_f32 v156, v156
    v_exp_f32 v157, v157
    v_exp_f32 v158, v158
    v_exp_f32 v159, v159
    v_pk_fma_f32 v[152:153], v[152:153], s[42:43], s[42:43] op_sel_hi:[1,0,0]
    v_pk_fma_f32 v[154:155], v[154:155], s[42:43], s[42:43] op_sel_hi:[1,0,0]
    v_pk_fma_f32 v[156:157], v[156:157], s[42:43], s[42:43] op_sel_hi:[1,0,0]
    v_pk_fma_f32 v[158:159], v[158:159], s[42:43], s[42:43] op_sel_hi:[1,0,0]
    v_rcp_f32 v152, v152
    v_rcp_f32 v153, v153
    v_rcp_f32 v154, v154
    v_rcp_f32 v155, v155
    v_rcp_f32 v156, v156
    v_rcp_f32 v157, v157
    v_rcp_f32 v158, v158
    v_rcp_f32 v159, v159
    v_pk_mul_f32 v[144:145], v[144:145], v[152:153]
    v_pk_mul_f32 v[146:147], v[146:147], v[154:155]
    v_pk_mul_f32 v[148:149], v[148:149], v[156:157]
    v_pk_mul_f32 v[150:151], v[150:151], v[158:159]
    v_cvt_pk_bf16_f32 v176, v144, v145
    v_cvt_pk_bf16_f32 v177, v146, v147
    v_cvt_pk_bf16_f32 v178, v148, v149
    v_cvt_pk_bf16_f32 v179, v150, v151
    buffer_store_dwordx4 v[176:179], v215, s[28:31], s10 offen
L_FIN:
L_END:
    s_endpgm
L_SLOW:
    s_waitcnt vmcnt(0) lgkmcnt(0)
    s_barrier
    s_mov_b32 s34, 8
    s_branch L_RELOAD
L_NEXT:
    s_add_u32 s33, s33, s34
L_RELOAD:
    v_lshlrev_b32 v214, 4, v212
    v_add_u32 v214, 75264, v214
    v_mov_b32 v184, 0
    v_mov_b32 v185, 0
    v_mov_b32 v186, 0
    v_mov_b32 v187, 0
    v_mov_b32 v188, 0x80000000
    v_mov_b32 v189, 0x80000000
    v_mov_b32 v190, 0x80000000
    v_mov_b32 v191, 0x80000000
    ds_write_b128 v214, v[188:191] offset:0
    s_movk_i32 s42, 504
    v_cmp_gt_u32 vcc, s42, v212
    s_nop 0
    s_and_saveexec_b64 s[84:85], vcc
    ds_write_b128 v214, v[188:191] offset:8192
    s_mov_b64 exec, s[84:85]
    ds_write_b128 v214, v[184:187] offset:16256
    ds_write_b128 v214, v[184:187] offset:24448
    ds_write_b128 v214, v[184:187] offset:32640
    ds_write_b128 v214, v[184:187] offset:40832
    s_movk_i32 s42, 271
    v_cmp_gt_u32 vcc, s42, v212
    s_nop 0
    s_and_saveexec_b64 s[84:85], vcc
    ds_write_b128 v214, v[184:187] offset:49024
    s_mov_b64 exec, s[84:85]
    s_mov_b64 s[4:5], -1
    s_mov_b64 s[6:7], -1
    s_mov_b64 s[96:97], -1
    s_mov_b64 s[98:99], -1
    s_mul_i32 s3, s33, 12
    v_add_u32 v216, s33, v75
    v_sub_u32 v215, s34, v75
    v_and_b32 v217, 0xffff, v224
    v_mad_u32_u24 v228, v217, 12, v74
    v_bfe_u32 v232, v224, 16, 15
    v_sub_u32 v232, v232, v216
    v_and_b32 v217, 0xffff, v225
    v_mad_u32_u24 v229, v217, 12, v74
    v_bfe_u32 v233, v225, 16, 15
    v_sub_u32 v233, v233, v216
    v_and_b32 v217, 0xffff, v226
    v_mad_u32_u24 v230, v217, 12, v74
    v_bfe_u32 v234, v226, 16, 15
    v_sub_u32 v234, v234, v216
    v_and_b32 v217, 0xffff, v227
    v_mad_u32_u24 v231, v217, 12, v74
    v_bfe_u32 v235, v227, 16, 15
    v_sub_u32 v235, v235, v216
    v_max_i32 v217, v232, v233
    v_max3_i32 v217, v217, v234, v235
    v_min_i32 v232, v215, v232
    v_min_i32 v233, v215, v233
    v_min_i32 v234, v215, v234
    v_min_i32 v235, v215, v235
    v_cmp_lt_i32 s[44:45], 0, v232
    v_cmp_lt_i32 s[46:47], 0, v233
    v_cmp_lt_i32 s[48:49], 0, v234
    v_cmp_lt_i32 s[50:51], 0, v235
    v_cmp_lt_i32 s[86:87], v215, v217
    v_min_i32 v217, v215, v217
    s_add_u32 s43, s3, 0
    s_and_b64 exec, s[44:45], s[4:5]
    buffer_load_dwordx3 v[104:106], v228, s[16:19], s43 offen offset:0
    s_add_u32 s43, s3, 38528
    s_and_b64 exec, s[46:47], s[6:7]
    buffer_load_dwordx3 v[108:110], v229, s[16:19], s43 offen offset:0
    s_add_u32 s43, s3, 77056
    s_and_b64 exec, s[48:49], s[96:97]
    buffer_load_dwordx3 v[112:114], v230, s[16:19], s43 offen offset:0
    s_add_u32 s43, s3, 115584
    s_and_b64 exec, s[50:51], s[98:99]
    buffer_load_dwordx3 v[116:118], v231, s[16:19], s43 offen offset:0
    s_mov_b64 exec, -1
    v_cmp_lt_i32 s[52:53], 8, v232
    v_cmp_lt_i32 s[54:55], 8, v233
    v_cmp_lt_i32 s[56:57], 8, v234
    v_cmp_lt_i32 s[58:59], 8, v235
    v_cmp_lt_i32 vcc, 24, v217
    v_cmp_lt_i32 s[84:85], 32, v217
    s_add_u32 s43, s3, 0
    s_and_b64 exec, s[52:53], s[4:5]
    buffer_load_dwordx3 v[120:122], v228, s[16:19], s43 offen offset:96
    s_add_u32 s43, s3, 38528
    s_and_b64 exec, s[54:55], s[6:7]
    buffer_load_dwordx3 v[124:126], v229, s[16:19], s43 offen offset:96
    s_add_u32 s43, s3, 77056
    s_and_b64 exec, s[56:57], s[96:97]
    buffer_load_dwordx3 v[128:130], v230, s[16:19], s43 offen offset:96
    s_add_u32 s43, s3, 115584
    s_and_b64 exec, s[58:59], s[98:99]
    buffer_load_dwordx3 v[132:134], v231, s[16:19], s43 offen offset:96
    s_cmp_lg_u64 vcc, 0
    s_cselect_b32 s40, 1, 0
    s_cmp_lg_u64 s[84:85], 0
    s_cselect_b32 s40, 2, s40
    s_mov_b64 exec, -1
    v_cmp_lt_i32 s[60:61], 16, v232
    v_cmp_lt_i32 s[62:63], 16, v233
    v_cmp_lt_i32 s[64:65], 16, v234
    v_cmp_lt_i32 s[66:67], 16, v235
    s_add_u32 s43, s3, 0
    s_and_b64 exec, s[60:61], s[4:5]
    buffer_load_dwordx3 v[136:138], v228, s[16:19], s43 offen offset:192
    s_add_u32 s43, s3, 38528
    s_and_b64 exec, s[62:63], s[6:7]
    buffer_load_dwordx3 v[140:142], v229, s[16:19], s43 offen offset:192
    s_add_u32 s43, s3, 77056
    s_and_b64 exec, s[64:65], s[96:97]
    buffer_load_dwordx3 v[144:146], v230, s[16:19], s43 offen offset:192
    s_add_u32 s43, s3, 115584
    s_and_b64 exec, s[66:67], s[98:99]
    buffer_load_dwordx3 v[148:150], v231, s[16:19], s43 offen offset:192
    s_cmp_lt_u32 s40, 1
    s_cbranch_scc1 L_LR3_b
    s_mov_b64 exec, -1
    v_cmp_lt_i32 s[68:69], 24, v232
    v_cmp_lt_i32 s[70:71], 24, v233
    v_cmp_lt_i32 s[72:73], 24, v234
    v_cmp_lt_i32 s[74:75], 24, v235
    s_add_u32 s43, s3, 0
    s_and_b64 exec, s[68:69], s[4:5]
    buffer_load_dwordx3 v[152:154], v228, s[16:19], s43 offen offset:288
    s_add_u32 s43, s3, 38528
    s_and_b64 exec, s[70:71], s[6:7]
    buffer_load_dwordx3 v[156:158], v229, s[16:19], s43 offen offset:288
    s_add_u32 s43, s3, 77056
    s_and_b64 exec, s[72:73], s[96:97]
    buffer_load_dwordx3 v[160:162], v230, s[16:19], s43 offen offset:288
    s_add_u32 s43, s3, 115584
    s_and_b64 exec, s[74:75], s[98:99]
    buffer_load_dwordx3 v[164:166], v231, s[16:19], s43 offen offset:288
    s_cmp_lt_u32 s40, 2
    s_cbranch_scc1 L_LR3_b
    s_mov_b64 exec, -1
    v_cmp_lt_i32 s[76:77], 32, v232
    v_cmp_lt_i32 s[78:79], 32, v233
    v_cmp_lt_i32 s[80:81], 32, v234
    v_cmp_lt_i32 s[82:83], 32, v235
    s_add_u32 s43, s3, 0
    s_and_b64 exec, s[76:77], s[4:5]
    buffer_load_dwordx3 v[168:170], v228, s[16:19], s43 offen offset:384
    s_add_u32 s43, s3, 38528
    s_and_b64 exec, s[78:79], s[6:7]
    buffer_load_dwordx3 v[172:174], v229, s[16:19], s43 offen offset:384
    s_add_u32 s43, s3, 77056
    s_and_b64 exec, s[80:81], s[96:97]
    buffer_load_dwordx3 v[176:178], v230, s[16:19], s43 offen offset:384
    s_add_u32 s43, s3, 115584
    s_and_b64 exec, s[82:83], s[98:99]
    buffer_load_dwordx3 v[180:182], v231, s[16:19], s43 offen offset:384
L_LR3_b:
    s_mov_b64 exec, -1
    s_waitcnt vmcnt(0) lgkmcnt(0)
    s_barrier
    s_branch L_SORTW
L_JAN:
    s_mov_b64 s[8:9], s[6:7]
    s_add_u32 s20, s8, 0xa00000
    s_addc_u32 s21, s9, 0
    s_mov_b64 s[24:25], s[4:5]
    s_mov_b64 s[16:17], s[8:9]
    s_mov_b64 s[12:13], s[68:69]
    s_sub_u32 s3, s58, 250
    s_mul_i32 s10, s3, 49152
    v_mov_b32 v4, 0
    v_mov_b32 v5, 0
    v_mov_b32 v6, 0
    v_mov_b32 v7, 0
    s_add_u32 s11, s10, 0
    buffer_store_dwordx4 v[4:7], v153, s[20:23], s11 offen sc1
    s_add_u32 s11, s10, 8192
    buffer_store_dwordx4 v[4:7], v153, s[20:23], s11 offen sc1
    s_add_u32 s11, s10, 16384
    buffer_store_dwordx4 v[4:7], v153, s[20:23], s11 offen sc1
    s_add_u32 s11, s10, 24576
    buffer_store_dwordx4 v[4:7], v153, s[20:23], s11 offen sc1
    s_add_u32 s11, s10, 32768
    buffer_store_dwordx4 v[4:7], v153, s[20:23], s11 offen sc1
    s_add_u32 s11, s10, 40960
    buffer_store_dwordx4 v[4:7], v153, s[20:23], s11 offen sc1
    s_waitcnt vmcnt(0)
    s_barrier
    s_cmp_eq_u32 s32, 0
    s_cselect_b64 exec, 1, 0
    buffer_store_byte v154, off, s[24:27], s3 sc1
    s_mov_b64 exec, -1
    s_branch L_CONS1
L_CODE_END:
.section .rodata,"a"
.p2align 6
.amdhsa_kernel standalone__edge_featured_mpnn_egc__graph_kernel
  .amdhsa_next_free_vgpr 256
  .amdhsa_next_free_sgpr 102
  .amdhsa_accum_offset 256
  .amdhsa_group_segment_fixed_size 0
  .amdhsa_kernarg_size 80
  .amdhsa_user_sgpr_count 2
  .amdhsa_user_sgpr_kernarg_segment_ptr 1
  .amdhsa_system_sgpr_workgroup_id_x 1
  .amdhsa_float_denorm_mode_32 3
  .amdhsa_dx10_clamp 0
.end_amdhsa_kernel
```
